```python
import torch

def _softmax(x, axis=-1):
    return torch.softmax(x, dim=axis)
def _gelu(x):
    return torch.nn.functional.gelu(x, approximate="tanh")
def _silu(x):
    return torch.nn.functional.silu(x)
def _sigmoid(x):
    return torch.sigmoid(x)
def _layernorm(x, axis=-1, eps=1e-5):
    m = x.mean(dim=axis, keepdim=True)
    v = x.var(dim=axis, keepdim=True, unbiased=False)
    return (x - m) / torch.sqrt(v + eps)
def _scatter_add(tgt, idx, src, axis=0):
    return tgt.clone().index_add_(axis, idx, src)
def _segment_sum(src, seg, n):
    out = torch.zeros((n,) + src.shape[1:], dtype=src.dtype)
    return out.index_add_(0, seg, src)
def _pad(x, pw):
    flat = tuple(v for pair in reversed(pw) for v in pair)
    return torch.nn.functional.pad(x, flat)

kernel_name = 'parallel_sum__spectral_gfnet__glu_gated_bilinear__prompt'

def setup_inputs():

    _w = (lambda a: (lambda t: t.to(torch.bfloat16) if t.is_floating_point() else t)(torch.as_tensor(a)))
    def _A_setup():
        B, S, D = 1, 2048, 512
        Df = D // 2 + 1
        return {
            "x": _w((lambda *s: torch.randn(*s, dtype=torch.bfloat16) * 0.05)(B, S, D)),
            "w_r": _w((lambda *s: torch.randn(*s, dtype=torch.bfloat16) * 0.4)(S, Df) * 0.02),
            "w_i": _w((lambda *s: torch.randn(*s, dtype=torch.bfloat16) * 0.4)(S, Df) * 0.02),
        }
    _A_in = _A_setup()

    def _B_setup():
        B, S, D, F = 1, 2048, 512, 1792
        return {
            "x": _w((lambda *s: torch.randn(*s, dtype=torch.bfloat16) * 0.05)(B, S, D)),
            "w_gate": _w((lambda *s: torch.randn(*s, dtype=torch.bfloat16) * 0.2)(D, F) * (D ** -0.5)),
            "w_up": _w((lambda *s: torch.randn(*s, dtype=torch.bfloat16) * 0.2)(D, F) * (D ** -0.5)),
            "w_down": _w((lambda *s: torch.randn(*s, dtype=torch.bfloat16) * 0.2)(F, D) * (F ** -0.5)),
        }
    _B_in = _B_setup()

    return {
        "A_x": _A_in["x"],
        "A_w_r": _A_in["w_r"],
        "A_w_i": _A_in["w_i"],
        "B_x": _B_in["x"],
        "B_w_gate": _B_in["w_gate"],
        "B_w_up": _B_in["w_up"],
        "B_w_down": _B_in["w_down"],
    }

def reference(A_x, A_w_r, A_w_i, B_x, B_w_gate, B_w_up, B_w_down):
    def _A_ref(x, w_r, w_i):
        B, S, D = x.shape
        X = (lambda x, axes=(-2,-1): torch.fft.rfft2(x.float(), dim=axes))(x, axes=(-2, -1))
        W = w_r + 1j * w_i
        X = X * W
        y = (lambda x, s, axes=(-2,-1): torch.fft.irfft2(x, s=s, dim=axes).to(torch.bfloat16))(X, (S, D), axes=(-2, -1))
        return y

    def _B_ref(x, w_gate, w_up, w_down):
        g = torch.einsum("bsd,df->bsf", x, w_gate)
        u = torch.einsum("bsd,df->bsf", x, w_up)
        h = g * u
        return torch.einsum("bsf,fd->bsd", h, w_down)

    x = A_x
    xn = _layernorm(x, axis=-1)
    return x + _A_ref(xn, A_w_r, A_w_i) + _B_ref(xn, B_w_gate, B_w_up, B_w_down)
```

```asm
; @launch grid=(256,1,1) block=(512,1,1) lds=163840
.amdgcn_target "amdgcn-amd-amdhsa--gfx950"
.text
.globl parallel_sum__spectral_gfnet__glu_gated_bilinear__prompt_kernel
.p2align 8
.type parallel_sum__spectral_gfnet__glu_gated_bilinear__prompt_kernel,@function
parallel_sum__spectral_gfnet__glu_gated_bilinear__prompt_kernel:
    s_cmp_ge_u32 s2, 256
    s_cbranch_scc1 L_END
    s_load_dwordx16 s[4:19], s[0:1], 0
    s_load_dwordx4 s[20:23], s[0:1], 64
    v_lshrrev_b32 v116, 6, v0
    v_and_b32 v106, 63, v0
    v_readfirstlane_b32 s57, v116
    s_and_b32 s61, s2, 7
    s_lshr_b32 s62, s2, 3
    v_lshlrev_b32 v107, 4, v106
    s_getpc_b64 s[40:41]
    s_add_u32 s40, s40, tabE@rel32@lo+4
    s_addc_u32 s41, s41, tabE@rel32@hi+12
    s_mov_b32 s42, 0x40000
    s_mov_b32 s43, 0x00020000
    s_mov_b32 s26, 0x200000
    s_mov_b32 s27, 0x00020000
    s_and_b32 s58, s57, 3
    s_cmp_lt_u32 s2, 32
    s_cbranch_scc1 L_A
    s_sub_u32 s3, s62, 4
    s_and_b32 s59, s61, 3
    s_lshl_b32 s59, s59, 2
    s_and_b32 s64, s3, 3
    s_add_u32 s59, s59, s64
    s_lshr_b32 s60, s61, 2
    s_mul_i32 s60, s60, 7
    s_lshr_b32 s64, s3, 2
    s_add_u32 s60, s60, s64
    s_sub_u32 s64, s2, 32
    s_lshl_b32 s64, s64, 1
    s_add_u32 s64, s64, s57
    s_sub_u32 s64, s64, 6
    s_cmp_lt_u32 s57, 6
    s_cbranch_scc1 L_NOEPF
    s_cmp_ge_u32 s64, 256
    s_cbranch_scc1 L_NOEPF
    s_lshl_b32 s64, s64, 10
    buffer_load_dwordx4 v[32:35], v107, s[40:43], s64 offen
L_NOEPF:
    v_lshrrev_b32 v116, 3, v106
    v_lshrrev_b32 v117, 4, v106
    v_and_b32 v118, 7, v106
    v_xor_b32 v118, v118, v117
    s_lshl_b32 s64, s59, 17
    s_lshl_b32 s65, s57, 14
    s_add_u32 s64, s64, s65
    v_lshlrev_b32 v119, 10, v116
    v_add_u32 v119, s64, v119
    v_lshl_add_u32 v102, v118, 4, v119
    v_xor_b32 v118, 4, v118
    v_lshl_add_u32 v103, v118, 4, v119
    v_add_u32 v103, 7168, v103
    v_and_b32 v117, 1, v117
    v_lshlrev_b32 v117, 2, v117
    v_and_b32 v118, 7, v106
    v_xor_b32 v118, v118, v117
    v_mul_u32_u24 v116, 3584, v116
    v_lshl_add_u32 v104, v118, 4, v116
    v_add_u32 v105, 27648, v104
    s_lshl_b32 s3, s57, 11
    s_lshl_b32 s69, s57, 10
    s_mov_b32 s31, 0x00020000
    s_mov_b32 s35, 0x00020000
    s_mov_b32 s64, 0
    s_mul_i32 s65, s57, 28672
    s_lshl_b32 s68, s60, 8
    s_sub_u32 s30, 1835008, s68
    s_mov_b32 s34, s30
    s_waitcnt lgkmcnt(0)
    s_add_u32 s28, s12, s68
    s_addc_u32 s29, s13, 0
    s_add_u32 s32, s14, s68
    s_addc_u32 s33, s15, 0
    s_mov_b32 s24, s4
    s_mov_b32 s25, s5
    s_add_u32 m0, s69, 49152
    s_nop 0
    buffer_load_dwordx4 v104, s[28:31], s65 offen lds
    s_add_u32 m0, s69, 57344
    s_nop 0
    buffer_load_dwordx4 v104, s[32:35], s65 offen lds
    s_add_u32 m0, s3, 32768
    s_nop 0
    buffer_load_dwordx4 v102, s[24:27], s64 offen offset:0 lds
    buffer_load_dwordx4 v103, s[24:27], s64 offen offset:1024 lds
    s_add_i32 s64, s64, 128
    s_add_i32 s65, s65, 229376
    s_getpc_b64 s[84:85]
L_parallel_sum_pc_1:
    s_sub_u32 s84, s84, L_parallel_sum_pc_1-parallel_sum__spectral_gfnet__glu_gated_bilinear__prompt_kernel
    s_subb_u32 s85, s85, 0
    s_lshr_b32 s86, s2, 3
    s_lshl_b32 s86, s86, 3
    s_add_u32 s86, s86, s57
    s_lshl_b32 s86, s86, 6
    s_add_u32 s87, s86, 32768
    s_min_u32 s87, s87, L_END-parallel_sum__spectral_gfnet__glu_gated_bilinear__prompt_kernel-64
    s_load_dword s88, s[84:85], s86
    s_add_u32 s86, s86, 16384
    s_load_dword s89, s[84:85], s86
    s_load_dword s90, s[84:85], s87
    s_lshr_b32 s78, s62, 2
    s_xor_b32 s79, s62, 12
    s_cmp_eq_u32 s78, 3
    s_cselect_b32 s62, s79, s62
    s_cmp_eq_u32 s78, 0
    s_cselect_b32 s62, s79, s62
    s_load_dword s56, s[22:23], 0x0
    s_lshl_b32 s78, s62, 3
    s_add_u32 s78, s78, s57
    s_lshl_b32 s78, s78, 16
    s_load_dword s80, s[22:23], s78
    s_and_b32 s79, s78, 0x3f0000
    s_add_u32 s79, s79, 0x1000000
    s_load_dword s81, s[22:23], s79
    s_and_b32 s79, s78, 0x1f0000
    s_load_dword s82, s[18:19], s79
    s_min_u32 s79, s79, 0x1b0000
    s_load_dword s83, s[16:17], s79
    s_mov_b32 s36, s22
    s_mov_b32 s37, s23
    s_mov_b32 s38, 0x1400000
    s_mov_b32 s39, 0x00020000
    s_mov_b32 s44, s16
    s_mov_b32 s45, s17
    s_mov_b32 s46, 0x1c0000
    s_mov_b32 s47, 0x00020000
    s_mov_b32 s48, s18
    s_mov_b32 s49, s19
    s_mov_b32 s50, 0x200000
    s_mov_b32 s51, 0x00020000
    v_mov_b32 v116, 0
    v_lshlrev_b32 v117, 2, v106
    v_add_u32 v117, 162816, v117
    ds_write_b32 v117, v116
    v_and_b32 v116, 31, v106
    v_lshrrev_b32 v117, 5, v106
    v_bfe_u32 v118, v106, 1, 3
    s_and_b32 s5, s58, 2
    v_xor_b32 v118, s5, v118
    s_lshl_b32 s5, s58, 12
    v_lshlrev_b32 v116, 7, v116
    v_add_u32 v116, s5, v116
    v_add_u32 v119, 0, v117
    v_xor_b32 v119, v119, v118
    v_lshl_add_u32 v96, v119, 4, v116
    v_add_u32 v119, 2, v117
    v_xor_b32 v119, v119, v118
    v_lshl_add_u32 v97, v119, 4, v116
    v_add_u32 v119, 4, v117
    v_xor_b32 v119, v119, v118
    v_lshl_add_u32 v98, v119, 4, v116
    v_add_u32 v119, 6, v117
    v_xor_b32 v119, v119, v118
    v_lshl_add_u32 v99, v119, 4, v116
    v_bfe_u32 v119, v106, 2, 2
    v_lshl_add_u32 v116, v117, 3, v119
    v_lshlrev_b32 v116, 7, v116
    v_bfe_u32 v118, v106, 4, 1
    v_lshl_add_u32 v116, v118, 5, v116
    v_and_b32 v118, 3, v106
    v_lshl_add_u32 v116, v118, 3, v116
    v_lshrrev_b32 v119, 1, v119
    s_lshr_b32 s4, s57, 2
    v_xor_b32 v119, s4, v119
    v_lshl_add_u32 v116, v119, 6, v116
    s_and_b32 s4, s58, 1
    s_lshl_b32 s4, s4, 13
    s_and_b32 s5, s58, 2
    s_lshl_b32 s5, s5, 10
    s_add_u32 s4, s4, s5
    v_add_u32 v100, s4, v116
    v_xor_b32 v101, 8192, v100
    v_xor_b32 v88, 2048, v100
    v_xor_b32 v89, 2048, v101
    v_lshrrev_b32 v116, 4, v106
    v_xor_b32 v116, v116, v106
    v_and_b32 v116, 1, v116
    v_cmp_eq_u32 vcc, 0, v116
    v_mov_b32 v117, 0x3f803f80
    s_nop 0
    v_cndmask_b32 v112, 0, v117, vcc
    v_mov_b32 v108, 0
    v_cndmask_b32 v113, 0, v117, vcc
    v_mov_b32 v109, 0
    v_cndmask_b32 v114, 0, v117, vcc
    v_mov_b32 v110, 0
    v_cndmask_b32 v115, 0, v117, vcc
    v_mov_b32 v111, 0
    s_add_u32 m0, s69, 81920
    s_nop 0
    buffer_load_dwordx4 v104, s[28:31], s65 offen lds
    s_add_u32 m0, s69, 90112
    s_nop 0
    buffer_load_dwordx4 v104, s[32:35], s65 offen lds
    s_add_u32 m0, s3, 65536
    s_nop 0
    buffer_load_dwordx4 v102, s[24:27], s64 offen offset:0 lds
    buffer_load_dwordx4 v103, s[24:27], s64 offen offset:1024 lds
    s_add_i32 s64, s64, 128
    s_add_i32 s65, s65, 229376
    s_sub_u32 s5, s2, 32
    s_lshl_b32 s5, s5, 1
    s_add_u32 s5, s5, s57
    s_sub_u32 s5, s5, 6
    s_lshr_b32 s10, s5, 5
    s_bfe_u32 s11, s5, 0x10002
    s_bfe_u32 s68, s5, 0x20003
    s_lshl_b32 s68, s68, 2
    s_and_b32 s19, s5, 3
    s_add_u32 s68, s68, s19
    s_sub_u32 s19, s5, 256
    s_lshr_b32 s66, s19, 1
    s_and_b32 s19, s19, 1
    s_cmp_ge_u32 s5, 256
    s_cselect_b32 s10, s66, s10
    s_cselect_b32 s11, s19, s11
    s_cselect_b32 s68, 16, s68
    s_cmp_eq_u32 s11, 1
    s_cselect_b32 s20, s8, s6
    s_cselect_b32 s21, s9, s7
    s_mov_b32 s22, 0x101000
    s_mov_b32 s23, 0x00020000
    s_mul_i32 s16, s10, 514
    s_and_b32 s16, s16, -16
    s_lshl_b32 s66, s68, 5
    s_add_u32 s16, s16, s66
    s_mul_i32 s17, s10, 34816
    s_mul_i32 s66, s11, 17408
    s_add_u32 s17, s17, s66
    s_lshl_b32 s66, s68, 10
    s_add_u32 s17, s17, s66
    s_add_u32 s17, s17, 0x200000
    s_and_b32 s18, s57, 1
    s_lshl_b32 s18, s18, 10
    s_add_u32 s18, s18, 139264
    s_cmp_lt_u32 s57, 6
    s_cselect_b32 s5, 0x1000, s5
    s_cselect_b32 s18, 141312, s18
    s_cmp_ge_u32 s5, 384
    s_cselect_b32 s16, 0x7000000, s16
    s_cselect_b32 s17, 0x7000000, s17
    v_lshrrev_b32 v116, 4, v106
    v_bfe_u32 v117, v106, 1, 2
    v_lshl_add_u32 v116, v116, 2, v117
    v_bfe_u32 v117, v106, 3, 1
    v_lshl_add_u32 v116, v117, 4, v116
    v_mul_u32_u24 v116, 32896, v116
    v_and_b32 v117, 1, v106
    v_lshl_add_u32 v44, v117, 4, v116
    v_lshrrev_b32 v116, 4, v106
    v_lshlrev_b32 v116, 8, v116
    v_and_b32 v117, 15, v106
    v_lshl_add_u32 v116, v117, 3, v116
    v_add_u32 v45, s18, v116
    s_cmp_ge_u32 s57, 4
    s_cselect_b32 s52, s8, s6
    s_cselect_b32 s53, s9, s7
    s_mov_b32 s54, 0x101000
    s_mov_b32 s55, 0x00020000
    s_lshr_b32 s6, s2, 2
    s_and_b32 s7, s2, 3
    v_bfe_u32 v116, v106, 3, 2
    v_lshrrev_b32 v117, 5, v106
    v_lshl_add_u32 v117, v117, 4, v116
    s_mov_b32 s9, 32896
    v_mul_lo_u32 v117, v117, s9
    v_and_b32 v118, 7, v106
    v_xor_b32 v118, v118, v116
    v_lshl_add_u32 v36, v118, 4, v117
    s_mul_i32 s10, s6, 514
    s_and_b32 s10, s10, -16
    s_mul_i32 s11, s58, 131584
    s_add_u32 s10, s10, s11
    s_lshl_b32 s11, s7, 7
    s_add_u32 s10, s10, s11
    s_lshl_b32 s11, s57, 10
    s_cmp_ge_u32 s58, 2
    s_cselect_b32 s12, s32, s28
    s_cselect_b32 s13, s33, s29
    s_mov_b32 s14, s30
    s_mov_b32 s15, 0x00020000
    s_lshl_b32 s66, s59, 2
    s_lshr_b32 s5, s57, 2
    s_lshl_b32 s5, s5, 1
    s_add_u32 s66, s66, s5
    s_and_b32 s5, s58, 1
    s_add_u32 s66, s66, s5
    s_mul_i32 s66, s66, 28672
    s_lshr_b32 s67, s2, 3
    s_sub_u32 s67, s67, 4
    s_lshl_b32 s67, s67, 2
    s_add_u32 s67, s67, s58
    s_lshl_b32 s67, s67, 11
    s_mul_i32 s5, s61, 229376
    s_add_u32 s67, s67, s5
    buffer_load_dwordx4 v[32:35], v104, s[12:15], s66 offen
    s_add_u32 m0, s69, 114688
    s_nop 0
    buffer_load_dwordx4 v104, s[28:31], s65 offen lds
    s_add_u32 m0, s69, 122880
    s_nop 0
    buffer_load_dwordx4 v104, s[32:35], s65 offen lds
    s_add_u32 m0, s3, 98304
    s_nop 0
    buffer_load_dwordx4 v102, s[24:27], s64 offen offset:0 lds
    buffer_load_dwordx4 v103, s[24:27], s64 offen offset:1024 lds
    s_add_i32 s64, s64, 128
    s_add_i32 s65, s65, 229376
    s_waitcnt lgkmcnt(0)
    s_add_u32 s56, s56, 0x9E3779B1
    s_waitcnt vmcnt(9)
    s_barrier
    s_cmp_ge_u32 s57, 4
    s_cbranch_scc1 L_GU_F
L_GU_H:
    ds_read_b128 v[128:131], v96 offset:32768
    ds_read_b64_tr_b16 v[64:65], v100 offset:49152
    ds_read_b64_tr_b16 v[66:67], v100 offset:49664
    ds_read_b64_tr_b16 v[68:69], v101 offset:49152
    ds_read_b64_tr_b16 v[70:71], v101 offset:49664
    ds_read_b128 v[132:135], v97 offset:32768
    ds_read_b64_tr_b16 v[72:73], v88 offset:49152
    ds_read_b64_tr_b16 v[74:75], v88 offset:49664
    ds_read_b64_tr_b16 v[76:77], v89 offset:49152
    ds_read_b64_tr_b16 v[78:79], v89 offset:49664
    s_waitcnt lgkmcnt(5)
    v_mfma_f32_32x32x16_bf16 v[0:15], v[64:67], v[128:131], 0
    ds_read_b128 v[136:139], v98 offset:32768
    ds_read_b64_tr_b16 v[80:81], v100 offset:53248
    ds_read_b64_tr_b16 v[82:83], v100 offset:53760
    s_add_u32 m0, s69, 16384
    s_nop 0
    buffer_load_dwordx4 v104, s[28:31], s65 offen lds
    s_add_u32 m0, s69, 24576
    s_nop 0
    buffer_load_dwordx4 v104, s[32:35], s65 offen lds
    v_mfma_f32_32x32x16_bf16 v[16:31], v[68:71], v[128:131], 0
    ds_read_b64_tr_b16 v[84:85], v101 offset:53248
    ds_read_b64_tr_b16 v[86:87], v101 offset:53760
    v_mfma_f32_16x16x32_bf16 v[108:111], v[64:67], v[112:115], v[108:111]
    s_waitcnt lgkmcnt(5)
    v_mfma_f32_32x32x16_bf16 v[0:15], v[72:75], v[132:135], v[0:15]
    ds_read_b128 v[140:143], v99 offset:32768
    ds_read_b64_tr_b16 v[64:65], v88 offset:53248
    ds_read_b64_tr_b16 v[66:67], v88 offset:53760
    v_mfma_f32_32x32x16_bf16 v[16:31], v[76:79], v[132:135], v[16:31]
    ds_read_b64_tr_b16 v[68:69], v89 offset:53248
    ds_read_b64_tr_b16 v[70:71], v89 offset:53760
    s_waitcnt vmcnt(7) lgkmcnt(5)
    v_xor_b32 v100, 0x10000, v100
    v_xor_b32 v101, 0x10000, v101
    v_xor_b32 v88, 0x10000, v88
    v_xor_b32 v89, 0x10000, v89
    v_xor_b32 v96, 0x10000, v96
    v_xor_b32 v97, 0x10000, v97
    v_xor_b32 v98, 0x10000, v98
    v_xor_b32 v99, 0x10000, v99
    s_barrier
    v_mfma_f32_32x32x16_bf16 v[0:15], v[80:83], v[136:139], v[0:15]
    ds_read_b128 v[144:147], v96 offset:0
    ds_read_b64_tr_b16 v[72:73], v100 offset:16384
    ds_read_b64_tr_b16 v[74:75], v100 offset:16896
    s_add_u32 m0, s3, 0
    s_nop 0
    buffer_load_dwordx4 v102, s[24:27], s64 offen offset:0 lds
    buffer_load_dwordx4 v103, s[24:27], s64 offen offset:1024 lds
    s_add_i32 s64, s64, 128
    s_add_i32 s65, s65, 229376
    v_mfma_f32_32x32x16_bf16 v[16:31], v[84:87], v[136:139], v[16:31]
    ds_read_b64_tr_b16 v[76:77], v101 offset:16384
    ds_read_b64_tr_b16 v[78:79], v101 offset:16896
    v_mfma_f32_16x16x32_bf16 v[108:111], v[80:83], v[112:115], v[108:111]
    s_waitcnt lgkmcnt(5)
    v_mfma_f32_32x32x16_bf16 v[0:15], v[64:67], v[140:143], v[0:15]
    ds_read_b128 v[148:151], v97 offset:0
    ds_read_b64_tr_b16 v[80:81], v88 offset:16384
    ds_read_b64_tr_b16 v[82:83], v88 offset:16896
    v_mfma_f32_32x32x16_bf16 v[16:31], v[68:71], v[140:143], v[16:31]
    ds_read_b64_tr_b16 v[84:85], v89 offset:16384
    ds_read_b64_tr_b16 v[86:87], v89 offset:16896
    s_waitcnt lgkmcnt(5)
    v_mfma_f32_32x32x16_bf16 v[0:15], v[72:75], v[144:147], v[0:15]
    ds_read_b128 v[152:155], v98 offset:0
    ds_read_b64_tr_b16 v[64:65], v100 offset:20480
    ds_read_b64_tr_b16 v[66:67], v100 offset:20992
    v_mfma_f32_32x32x16_bf16 v[16:31], v[76:79], v[144:147], v[16:31]
    ds_read_b64_tr_b16 v[68:69], v101 offset:20480
    ds_read_b64_tr_b16 v[70:71], v101 offset:20992
    v_mfma_f32_16x16x32_bf16 v[108:111], v[72:75], v[112:115], v[108:111]
    s_waitcnt lgkmcnt(5)
    v_mfma_f32_32x32x16_bf16 v[0:15], v[80:83], v[148:151], v[0:15]
    ds_read_b128 v[156:159], v99 offset:0
    ds_read_b64_tr_b16 v[72:73], v88 offset:20480
    ds_read_b64_tr_b16 v[74:75], v88 offset:20992
    s_add_u32 m0, s11, 131072
    s_nop 0
    buffer_load_dwordx4 v36, s[52:55], s10 offen nt lds
    v_mfma_f32_32x32x16_bf16 v[16:31], v[84:87], v[148:151], v[16:31]
    ds_read_b64_tr_b16 v[76:77], v89 offset:20480
    ds_read_b64_tr_b16 v[78:79], v89 offset:20992
    s_mov_b32 m0, s18
    s_nop 0
    buffer_load_dwordx4 v44, s[20:23], s16 offen nt lds
    s_waitcnt vmcnt(6) lgkmcnt(5)
    s_barrier
    v_mfma_f32_32x32x16_bf16 v[0:15], v[64:67], v[152:155], v[0:15]
    ds_read_b128 v[160:163], v96 offset:32768
    ds_read_b64_tr_b16 v[80:81], v100 offset:49152
    ds_read_b64_tr_b16 v[82:83], v100 offset:49664
    s_add_u32 m0, s69, 49152
    s_nop 0
    buffer_load_dwordx4 v104, s[28:31], s65 offen lds
    s_add_u32 m0, s69, 57344
    s_nop 0
    buffer_load_dwordx4 v104, s[32:35], s65 offen lds
    v_lshrrev_b32 v116, 4, v106
    v_lshlrev_b32 v37, 10, v116
    v_mfma_f32_32x32x16_bf16 v[16:31], v[68:71], v[152:155], v[16:31]
    ds_read_b64_tr_b16 v[84:85], v101 offset:49152
    ds_read_b64_tr_b16 v[86:87], v101 offset:49664
    v_mfma_f32_16x16x32_bf16 v[108:111], v[64:67], v[112:115], v[108:111]
    v_bfe_u32 v117, v106, 2, 2
    v_lshl_add_u32 v37, v117, 7, v37
    v_bfe_u32 v118, v106, 1, 1
    s_lshl_b32 s11, s58, 1
    v_add_u32 v118, s11, v118
    s_waitcnt lgkmcnt(5)
    v_mfma_f32_32x32x16_bf16 v[0:15], v[72:75], v[156:159], v[0:15]
    ds_read_b128 v[164:167], v97 offset:32768
    ds_read_b64_tr_b16 v[64:65], v88 offset:49152
    ds_read_b64_tr_b16 v[66:67], v88 offset:49664
    v_xor_b32 v118, v118, v117
    v_lshl_add_u32 v37, v118, 4, v37
    v_and_b32 v118, 1, v106
    v_mfma_f32_32x32x16_bf16 v[16:31], v[76:79], v[156:159], v[16:31]
    ds_read_b64_tr_b16 v[68:69], v89 offset:49152
    ds_read_b64_tr_b16 v[70:71], v89 offset:49664
    v_lshl_add_u32 v37, v118, 3, v37
    s_lshr_b32 s8, s57, 2
    s_lshl_b32 s11, s8, 12
    s_waitcnt lgkmcnt(5)
    v_mfma_f32_32x32x16_bf16 v[0:15], v[80:83], v[160:163], v[0:15]
    ds_read_b128 v[168:171], v98 offset:32768
    ds_read_b64_tr_b16 v[72:73], v100 offset:53248
    ds_read_b64_tr_b16 v[74:75], v100 offset:53760
    s_add_u32 m0, s3, 32768
    s_nop 0
    buffer_load_dwordx4 v102, s[24:27], s64 offen offset:0 lds
    buffer_load_dwordx4 v103, s[24:27], s64 offen offset:1024 lds
    s_add_i32 s64, s64, 128
    s_add_i32 s65, s65, 229376
    s_add_u32 s11, s11, 131072
    v_mfma_f32_32x32x16_bf16 v[16:31], v[84:87], v[160:163], v[16:31]
    ds_read_b64_tr_b16 v[76:77], v101 offset:53248
    ds_read_b64_tr_b16 v[78:79], v101 offset:53760
    v_mfma_f32_16x16x32_bf16 v[108:111], v[80:83], v[112:115], v[108:111]
    v_add_u32 v37, s11, v37
    v_and_b32 v118, 15, v106
    v_lshlrev_b32 v118, 6, v118
    v_lshl_add_u32 v38, v116, 4, v118
    s_mul_i32 s63, s6, 34816
    s_mul_i32 s8, s8, 17408
    s_waitcnt lgkmcnt(5)
    v_mfma_f32_32x32x16_bf16 v[0:15], v[64:67], v[164:167], v[0:15]
    ds_read_b128 v[172:175], v99 offset:32768
    ds_read_b64_tr_b16 v[80:81], v88 offset:53248
    ds_read_b64_tr_b16 v[82:83], v88 offset:53760
    buffer_load_dwordx4 v[32:35], v104, s[12:15], s66 offen offset:128
    s_add_u32 s63, s63, s8
    s_lshl_b32 s8, s7, 12
    s_add_u32 s63, s63, s8
    v_mfma_f32_32x32x16_bf16 v[16:31], v[68:71], v[164:167], v[16:31]
    ds_read_b64_tr_b16 v[84:85], v89 offset:53248
    ds_read_b64_tr_b16 v[86:87], v89 offset:53760
    s_lshl_b32 s8, s58, 10
    s_add_u32 s63, s63, s8
    s_add_u32 s63, s63, 0x200000
    s_waitcnt vmcnt(7) lgkmcnt(5)
    v_xor_b32 v100, 0x10000, v100
    v_xor_b32 v101, 0x10000, v101
    v_xor_b32 v88, 0x10000, v88
    v_xor_b32 v89, 0x10000, v89
    v_xor_b32 v96, 0x10000, v96
    v_xor_b32 v97, 0x10000, v97
    v_xor_b32 v98, 0x10000, v98
    v_xor_b32 v99, 0x10000, v99
    s_barrier
    v_mfma_f32_32x32x16_bf16 v[0:15], v[72:75], v[168:171], v[0:15]
    ds_read_b128 v[176:179], v96 offset:0
    ds_read_b64_tr_b16 v[64:65], v100 offset:16384
    ds_read_b64_tr_b16 v[66:67], v100 offset:16896
    s_add_u32 m0, s69, 81920
    s_nop 0
    buffer_load_dwordx4 v104, s[28:31], s65 offen lds
    s_add_u32 m0, s69, 90112
    s_nop 0
    buffer_load_dwordx4 v104, s[32:35], s65 offen lds
    v_mfma_f32_32x32x16_bf16 v[16:31], v[76:79], v[168:171], v[16:31]
    ds_read_b64_tr_b16 v[68:69], v101 offset:16384
    ds_read_b64_tr_b16 v[70:71], v101 offset:16896
    v_mfma_f32_16x16x32_bf16 v[108:111], v[72:75], v[112:115], v[108:111]
    s_waitcnt lgkmcnt(5)
    v_mfma_f32_32x32x16_bf16 v[0:15], v[80:83], v[172:175], v[0:15]
    ds_read_b128 v[180:183], v97 offset:0
    ds_read_b64_tr_b16 v[72:73], v88 offset:16384
    ds_read_b64_tr_b16 v[74:75], v88 offset:16896
    v_mfma_f32_32x32x16_bf16 v[16:31], v[84:87], v[172:175], v[16:31]
    ds_read_b64_tr_b16 v[76:77], v89 offset:16384
    ds_read_b64_tr_b16 v[78:79], v89 offset:16896
    s_waitcnt lgkmcnt(5)
    v_mfma_f32_32x32x16_bf16 v[0:15], v[64:67], v[176:179], v[0:15]
    ds_read_b128 v[184:187], v98 offset:0
    ds_read_b64_tr_b16 v[80:81], v100 offset:20480
    ds_read_b64_tr_b16 v[82:83], v100 offset:20992
    s_add_u32 m0, s3, 65536
    s_nop 0
    buffer_load_dwordx4 v102, s[24:27], s64 offen offset:0 lds
    buffer_load_dwordx4 v103, s[24:27], s64 offen offset:1024 lds
    s_add_i32 s64, s64, 128
    s_add_i32 s65, s65, 229376
    v_mfma_f32_32x32x16_bf16 v[16:31], v[68:71], v[176:179], v[16:31]
    ds_read_b64_tr_b16 v[84:85], v101 offset:20480
    ds_read_b64_tr_b16 v[86:87], v101 offset:20992
    v_mfma_f32_16x16x32_bf16 v[108:111], v[64:67], v[112:115], v[108:111]
    s_waitcnt lgkmcnt(5)
    v_mfma_f32_32x32x16_bf16 v[0:15], v[72:75], v[180:183], v[0:15]
    ds_read_b128 v[188:191], v99 offset:0
    ds_read_b64_tr_b16 v[64:65], v88 offset:20480
    ds_read_b64_tr_b16 v[66:67], v88 offset:20992
    s_lshl_b32 s17, s58, 13
    s_lshl_b32 s18, s58, 14
    s_lshr_b32 s19, s62, 2
    s_lshl_b32 s19, s19, 7
    v_mfma_f32_32x32x16_bf16 v[16:31], v[76:79], v[180:183], v[16:31]
    ds_read_b64_tr_b16 v[68:69], v89 offset:20480
    ds_read_b64_tr_b16 v[70:71], v89 offset:20992
    s_add_u32 s18, s18, s19
    v_lshrrev_b32 v116, 3, v106
    v_bfe_u32 v117, v106, 2, 1
    v_bfe_u32 v118, v106, 4, 1
    s_waitcnt vmcnt(5) lgkmcnt(5)
    s_barrier
    v_mfma_f32_32x32x16_bf16 v[0:15], v[80:83], v[184:187], v[0:15]
    ds_read_b128 v[192:195], v96 offset:32768
    ds_read_b64_tr_b16 v[72:73], v100 offset:49152
    ds_read_b64_tr_b16 v[74:75], v100 offset:49664
    s_add_u32 m0, s69, 114688
    s_nop 0
    buffer_load_dwordx4 v104, s[28:31], s65 offen lds
    s_add_u32 m0, s69, 122880
    s_nop 0
    buffer_load_dwordx4 v104, s[32:35], s65 offen lds
    ds_read_b64_tr_b16 v[40:41], v37
    ds_read_b64_tr_b16 v[42:43], v37 offset:512
    v_xor_b32 v117, v117, v118
    v_mfma_f32_32x32x16_bf16 v[16:31], v[84:87], v[184:187], v[16:31]
    ds_read_b64_tr_b16 v[76:77], v101 offset:49152
    ds_read_b64_tr_b16 v[78:79], v101 offset:49664
    v_mfma_f32_16x16x32_bf16 v[108:111], v[80:83], v[112:115], v[108:111]
    v_lshlrev_b32 v117, 6, v117
    v_and_b32 v118, 3, v106
    v_lshl_add_u32 v117, v118, 4, v117
    v_lshl_add_u32 v120, v116, 10, v117
    v_add_u32 v121, 7168, v120
    v_bfe_u32 v117, v106, 2, 2
    v_lshrrev_b32 v118, 5, v106
    s_waitcnt lgkmcnt(5)
    v_mfma_f32_32x32x16_bf16 v[0:15], v[64:67], v[188:191], v[0:15]
    ds_read_b128 v[196:199], v97 offset:32768
    ds_read_b64_tr_b16 v[80:81], v88 offset:49152
    ds_read_b64_tr_b16 v[82:83], v88 offset:49664
    v_lshl_add_u32 v118, v118, 2, v117
    v_lshlrev_b32 v118, 7, v118
    v_bfe_u32 v119, v106, 3, 1
    v_lshl_add_u32 v119, v119, 6, v118
    v_mfma_f32_32x32x16_bf16 v[16:31], v[68:71], v[188:191], v[16:31]
    ds_read_b64_tr_b16 v[84:85], v89 offset:49152
    ds_read_b64_tr_b16 v[86:87], v89 offset:49664
    v_bfe_u32 v117, v106, 4, 1
    v_lshl_add_u32 v119, v117, 5, v119
    v_and_b32 v117, 3, v106
    v_lshl_add_u32 v119, v117, 3, v119
    s_waitcnt lgkmcnt(5)
    v_mfma_f32_32x32x16_bf16 v[0:15], v[72:75], v[192:195], v[0:15]
    ds_read_b128 v[200:203], v98 offset:32768
    ds_read_b64_tr_b16 v[64:65], v100 offset:53248
    ds_read_b64_tr_b16 v[66:67], v100 offset:53760
    buffer_store_dwordx4 v[40:43], v38, s[36:39], s63 offen sc1
    s_add_u32 m0, s3, 98304
    s_nop 0
    buffer_load_dwordx4 v102, s[24:27], s64 offen offset:0 lds
    buffer_load_dwordx4 v103, s[24:27], s64 offen offset:1024 lds
    s_add_i32 s64, s64, 128
    s_add_i32 s65, s65, 229376
    s_and_b32 s7, s58, 2
    v_mfma_f32_32x32x16_bf16 v[16:31], v[76:79], v[192:195], v[16:31]
    ds_read_b64_tr_b16 v[68:69], v101 offset:53248
    ds_read_b64_tr_b16 v[70:71], v101 offset:53760
    v_mfma_f32_16x16x32_bf16 v[108:111], v[72:75], v[112:115], v[108:111]
    s_lshl_b32 s7, s7, 5
    v_xor_b32 v119, s7, v119
    v_add_u32 v119, s17, v119
    v_add_u32 v122, 32768, v119
    v_xor_b32 v123, 64, v122
    v_add_u32 v124, 65536, v122
    s_waitcnt lgkmcnt(5)
    v_mfma_f32_32x32x16_bf16 v[0:15], v[80:83], v[196:199], v[0:15]
    ds_read_b128 v[204:207], v99 offset:32768
    ds_read_b64_tr_b16 v[72:73], v88 offset:53248
    ds_read_b64_tr_b16 v[74:75], v88 offset:53760
    buffer_load_dwordx4 v[32:35], v107, s[44:47], s67 offen
    s_add_u32 s67, s67, 1024
    v_xor_b32 v125, 64, v124
    s_lshl_b32 s8, s61, 2
    s_and_b32 s9, s62, 3
    v_mfma_f32_32x32x16_bf16 v[16:31], v[84:87], v[196:199], v[16:31]
    ds_read_b64_tr_b16 v[76:77], v89 offset:53248
    ds_read_b64_tr_b16 v[78:79], v89 offset:53760
    s_add_u32 s8, s8, s9
    s_mul_i32 s10, s8, 224
    s_add_u32 s10, s10, s58
    s_lshl_b32 s10, s10, 10
    s_add_u32 s10, s10, 0x600000
    s_waitcnt vmcnt(6) lgkmcnt(5)
    v_xor_b32 v100, 0x10000, v100
    v_xor_b32 v101, 0x10000, v101
    v_xor_b32 v88, 0x10000, v88
    v_xor_b32 v89, 0x10000, v89
    v_xor_b32 v96, 0x10000, v96
    v_xor_b32 v97, 0x10000, v97
    v_xor_b32 v98, 0x10000, v98
    v_xor_b32 v99, 0x10000, v99
    s_barrier
    v_mfma_f32_32x32x16_bf16 v[0:15], v[64:67], v[200:203], v[0:15]
    ds_read_b128 v[208:211], v96 offset:0
    ds_read_b64_tr_b16 v[80:81], v100 offset:16384
    ds_read_b64_tr_b16 v[82:83], v100 offset:16896
    s_add_u32 m0, s69, 16384
    s_nop 0
    buffer_load_dwordx4 v104, s[28:31], s65 offen lds
    s_add_u32 m0, s69, 24576
    s_nop 0
    buffer_load_dwordx4 v104, s[32:35], s65 offen lds
    buffer_load_dwordx4 v[32:35], v107, s[44:47], s67 offen
    s_add_u32 s67, s67, 1024
    s_and_b32 s7, s58, 1
    v_mfma_f32_32x32x16_bf16 v[16:31], v[68:71], v[200:203], v[16:31]
    ds_read_b64_tr_b16 v[84:85], v101 offset:16384
    ds_read_b64_tr_b16 v[86:87], v101 offset:16896
    v_mfma_f32_16x16x32_bf16 v[108:111], v[64:67], v[112:115], v[108:111]
    s_mul_i32 s7, s7, 114688
    s_sub_u32 s11, s10, s7
    s_add_u32 s11, s11, 114688
    s_add_u32 s10, s10, s7
    s_lshr_b32 s9, s8, 1
    s_lshl_b32 s9, s9, 11
    s_add_u32 s9, s9, 0x60000
    s_waitcnt lgkmcnt(5)
    v_mfma_f32_32x32x16_bf16 v[0:15], v[72:75], v[204:207], v[0:15]
    ds_read_b128 v[212:215], v97 offset:0
    ds_read_b64_tr_b16 v[64:65], v88 offset:16384
    ds_read_b64_tr_b16 v[66:67], v88 offset:16896
    s_lshl_b32 s16, s8, 13
    s_lshr_b32 s7, s58, 1
    s_lshl_b32 s7, s7, 12
    s_add_u32 s16, s16, s7
    v_mfma_f32_32x32x16_bf16 v[16:31], v[76:79], v[204:207], v[16:31]
    ds_read_b64_tr_b16 v[68:69], v89 offset:16384
    ds_read_b64_tr_b16 v[70:71], v89 offset:16896
    s_add_u32 s16, s16, 0x80000
    v_min_u32 v126, 27, v106
    v_lshlrev_b32 v126, 7, v126
    s_lshl_b32 s12, s8, 16
    s_waitcnt lgkmcnt(5)
    v_mfma_f32_32x32x16_bf16 v[0:15], v[80:83], v[208:211], v[0:15]
    ds_read_b128 v[216:219], v98 offset:0
    ds_read_b64_tr_b16 v[72:73], v100 offset:20480
    ds_read_b64_tr_b16 v[74:75], v100 offset:20992
    s_add_u32 m0, s3, 0
    s_nop 0
    buffer_load_dwordx4 v102, s[24:27], s64 offen offset:0 lds
    buffer_load_dwordx4 v103, s[24:27], s64 offen offset:1024 lds
    s_mul_i32 s65, s57, 57344
    s_add_u32 s65, s65, 128
    s_and_b32 s7, s58, 1
    v_mfma_f32_32x32x16_bf16 v[16:31], v[84:87], v[208:211], v[16:31]
    ds_read_b64_tr_b16 v[76:77], v101 offset:20480
    ds_read_b64_tr_b16 v[78:79], v101 offset:20992
    v_mfma_f32_16x16x32_bf16 v[108:111], v[80:83], v[112:115], v[108:111]
    s_lshl_b32 s7, s7, 15
    s_add_u32 s12, s12, s7
    s_add_u32 s12, s12, s19
    s_lshr_b32 s7, s58, 1
    s_lshl_b32 s7, s7, 6
    s_add_u32 s12, s12, s7
    s_waitcnt lgkmcnt(5)
    v_mfma_f32_32x32x16_bf16 v[0:15], v[64:67], v[212:215], v[0:15]
    ds_read_b128 v[220:223], v99 offset:0
    ds_read_b64_tr_b16 v[80:81], v88 offset:20480
    ds_read_b64_tr_b16 v[82:83], v88 offset:20992
    v_mfma_f32_32x32x16_bf16 v[16:31], v[68:71], v[212:215], v[16:31]
    ds_read_b64_tr_b16 v[84:85], v89 offset:20480
    ds_read_b64_tr_b16 v[86:87], v89 offset:20992
    s_waitcnt vmcnt(6) lgkmcnt(5)
    s_barrier
    v_mfma_f32_32x32x16_bf16 v[0:15], v[72:75], v[216:219], v[0:15]
    ds_read_b128 v[224:227], v96 offset:32768
    ds_read_b64_tr_b16 v[64:65], v100 offset:49152
    ds_read_b64_tr_b16 v[66:67], v100 offset:49664
    s_add_u32 m0, s3, 32768
    s_nop 0
    buffer_load_dwordx4 v104, s[28:31], s65 offen offset:0 lds
    buffer_load_dwordx4 v105, s[28:31], s65 offen offset:1024 lds
    s_lshl_b32 s21, s59, 2
    s_add_u32 s21, s21, s58
    s_mul_i32 s20, s21, 112
    s_lshl_b32 s21, s21, 8
    v_mfma_f32_32x32x16_bf16 v[16:31], v[76:79], v[216:219], v[16:31]
    ds_read_b64_tr_b16 v[68:69], v101 offset:49152
    ds_read_b64_tr_b16 v[70:71], v101 offset:49664
    v_mfma_f32_16x16x32_bf16 v[108:111], v[72:75], v[112:115], v[108:111]
    s_add_u32 s21, s21, 0x10000
    v_and_b32 v90, 31, v106
    v_lshlrev_b32 v92, 2, v90
    v_lshlrev_b32 v90, 3, v90
    s_lshl_b32 s22, s60, 3
    s_add_u32 s20, s20, s22
    s_waitcnt lgkmcnt(5)
    v_mfma_f32_32x32x16_bf16 v[0:15], v[80:83], v[220:223], v[0:15]
    ds_read_b128 v[228:231], v97 offset:32768
    ds_read_b64_tr_b16 v[72:73], v88 offset:49152
    ds_read_b64_tr_b16 v[74:75], v88 offset:49664
    s_lshl_b32 s20, s20, 10
    s_add_u32 s20, s20, 0x600000
    s_lshl_b32 s22, s59, 4
    s_add_u32 s22, s22, s60
    s_lshl_b32 s22, s22, 7
    v_mfma_f32_32x32x16_bf16 v[16:31], v[84:87], v[220:223], v[16:31]
    ds_read_b64_tr_b16 v[76:77], v89 offset:49152
    ds_read_b64_tr_b16 v[78:79], v89 offset:49664
    s_add_u32 s22, s22, 0x60000
    v_and_b32 v91, 15, v106
    v_lshlrev_b32 v91, 6, v91
    v_lshrrev_b32 v116, 4, v106
    v_lshl_add_u32 v91, v116, 4, v91
    s_waitcnt lgkmcnt(5)
    v_mfma_f32_32x32x16_bf16 v[0:15], v[64:67], v[224:227], v[0:15]
    ds_read_b128 v[232:235], v98 offset:32768
    ds_read_b64_tr_b16 v[80:81], v100 offset:53248
    ds_read_b64_tr_b16 v[82:83], v100 offset:53760
    s_add_u32 m0, s3, 49152
    s_nop 0
    buffer_load_dwordx4 v104, s[32:35], s65 offen offset:0 lds
    buffer_load_dwordx4 v105, s[32:35], s65 offen offset:1024 lds
    s_add_u32 s65, s65, 458752
    s_and_b32 s23, s58, 1
    s_lshl_b32 s23, s23, 7
    s_add_u32 s23, s23, 153600
    v_mfma_f32_32x32x16_bf16 v[16:31], v[68:71], v[224:227], v[16:31]
    ds_read_b64_tr_b16 v[84:85], v101 offset:53248
    ds_read_b64_tr_b16 v[86:87], v101 offset:53760
    v_mfma_f32_16x16x32_bf16 v[108:111], v[64:67], v[112:115], v[108:111]
    v_add_u32 v92, s23, v92
    s_and_b32 s7, s58, 2
    s_lshl_b32 s7, s7, 8
    s_add_u32 s23, s23, s7
    v_add_u32 v91, s23, v91
    v_xor_b32 v93, 128, v92
    s_waitcnt lgkmcnt(5)
    v_mfma_f32_32x32x16_bf16 v[0:15], v[72:75], v[228:231], v[0:15]
    ds_read_b128 v[236:239], v99 offset:32768
    ds_read_b64_tr_b16 v[64:65], v88 offset:53248
    ds_read_b64_tr_b16 v[66:67], v88 offset:53760
    buffer_load_dwordx2 v[118:119], v90, s[36:39], s21 offen sc1
    v_mfma_f32_32x32x16_bf16 v[16:31], v[76:79], v[228:231], v[16:31]
    ds_read_b64_tr_b16 v[68:69], v89 offset:53248
    ds_read_b64_tr_b16 v[70:71], v89 offset:53760
    s_waitcnt vmcnt(5) lgkmcnt(5)
    v_xor_b32 v100, 0x10000, v100
    v_xor_b32 v101, 0x10000, v101
    v_xor_b32 v88, 0x10000, v88
    v_xor_b32 v89, 0x10000, v89
    v_xor_b32 v96, 0x10000, v96
    v_xor_b32 v97, 0x10000, v97
    v_xor_b32 v98, 0x10000, v98
    v_xor_b32 v99, 0x10000, v99
    s_barrier
    v_mfma_f32_32x32x16_bf16 v[0:15], v[80:83], v[232:235], v[0:15]
    ds_read_b128 v[240:243], v96 offset:0
    ds_read_b64_tr_b16 v[72:73], v100 offset:16384
    ds_read_b64_tr_b16 v[74:75], v100 offset:16896
    s_add_u32 m0, s3, 65536
    s_nop 0
    buffer_load_dwordx4 v104, s[28:31], s65 offen offset:0 lds
    buffer_load_dwordx4 v105, s[28:31], s65 offen offset:1024 lds
    s_lshl_b32 s14, s2, 7
    s_add_u32 s14, s14, 0x32000
    s_cmp_lg_u32 s58, 0
    s_cselect_b32 s14, 0x7000000, s14
    v_mov_b32 v116, 0
    v_mov_b32 v117, s56
    s_mov_b64 exec, 1
    buffer_store_dword v117, v116, s[36:39], s14 offen sc1
    s_mov_b64 exec, -1
    v_mfma_f32_32x32x16_bf16 v[16:31], v[84:87], v[232:235], v[16:31]
    ds_read_b64_tr_b16 v[76:77], v101 offset:16384
    ds_read_b64_tr_b16 v[78:79], v101 offset:16896
    v_mfma_f32_16x16x32_bf16 v[108:111], v[80:83], v[112:115], v[108:111]
    s_waitcnt lgkmcnt(5)
    v_mfma_f32_32x32x16_bf16 v[0:15], v[64:67], v[236:239], v[0:15]
    ds_read_b128 v[244:247], v97 offset:0
    ds_read_b64_tr_b16 v[80:81], v88 offset:16384
    ds_read_b64_tr_b16 v[82:83], v88 offset:16896
    v_mfma_f32_32x32x16_bf16 v[16:31], v[68:71], v[236:239], v[16:31]
    ds_read_b64_tr_b16 v[84:85], v89 offset:16384
    ds_read_b64_tr_b16 v[86:87], v89 offset:16896
    s_waitcnt lgkmcnt(5)
    v_mfma_f32_32x32x16_bf16 v[0:15], v[72:75], v[240:243], v[0:15]
    ds_read_b128 v[248:251], v98 offset:0
    ds_read_b64_tr_b16 v[64:65], v100 offset:20480
    ds_read_b64_tr_b16 v[66:67], v100 offset:20992
    s_add_u32 m0, s3, 81920
    s_nop 0
    buffer_load_dwordx4 v104, s[32:35], s65 offen offset:0 lds
    buffer_load_dwordx4 v105, s[32:35], s65 offen offset:1024 lds
    s_add_u32 s65, s65, 458752
    v_mfma_f32_32x32x16_bf16 v[16:31], v[76:79], v[240:243], v[16:31]
    ds_read_b64_tr_b16 v[68:69], v101 offset:20480
    ds_read_b64_tr_b16 v[70:71], v101 offset:20992
    v_mfma_f32_16x16x32_bf16 v[108:111], v[72:75], v[112:115], v[108:111]
    s_waitcnt lgkmcnt(5)
    v_mfma_f32_32x32x16_bf16 v[0:15], v[80:83], v[244:247], v[0:15]
    ds_read_b128 v[252:255], v99 offset:0
    ds_read_b64_tr_b16 v[72:73], v88 offset:20480
    ds_read_b64_tr_b16 v[74:75], v88 offset:20992
    s_and_b32 s4, s58, 1
    s_lshl_b32 s4, s4, 13
    v_mfma_f32_32x32x16_bf16 v[16:31], v[84:87], v[244:247], v[16:31]
    ds_read_b64_tr_b16 v[76:77], v89 offset:20480
    ds_read_b64_tr_b16 v[78:79], v89 offset:20992
    s_xor_b32 s5, s4, 8192
    s_waitcnt vmcnt(6) lgkmcnt(0)
    v_add_u32 v100, s4, v100
    v_add_u32 v101, s5, v101
    v_add_u32 v88, s4, v88
    v_add_u32 v89, s5, v89
    s_barrier
    v_mfma_f32_32x32x16_bf16 v[0:15], v[64:67], v[248:251], v[0:15]
    ds_read_b64_tr_b16 v[80:81], v100 offset:32768
    ds_read_b64_tr_b16 v[82:83], v100 offset:33280
    ds_read_b64_tr_b16 v[84:85], v101 offset:32768
    s_lshr_b32 s13, s2, 3
    s_sub_u32 s13, s13, 4
    s_lshl_b32 s13, s13, 2
    s_add_u32 s13, s13, s58
    s_lshl_b32 s13, s13, 14
    s_add_u32 s13, s13, 384
    buffer_load_dwordx4 v[96:99], v120, s[44:47], s13 offen
    v_mfma_f32_32x32x16_bf16 v[16:31], v[68:71], v[248:251], v[16:31]
    ds_read_b64_tr_b16 v[86:87], v101 offset:33280
    v_mfma_f32_16x16x32_bf16 v[108:111], v[64:67], v[112:115], v[108:111]
    s_waitcnt lgkmcnt(4)
    v_mfma_f32_32x32x16_bf16 v[0:15], v[72:75], v[252:255], v[0:15]
    ds_read_b64_tr_b16 v[64:65], v88 offset:32768
    ds_read_b64_tr_b16 v[66:67], v88 offset:33280
    ds_read_b64_tr_b16 v[68:69], v89 offset:32768
    buffer_load_dwordx4 v[96:99], v121, s[44:47], s13 offen offset:1024
    v_mfma_f32_32x32x16_bf16 v[16:31], v[76:79], v[252:255], v[16:31]
    ds_read_b64_tr_b16 v[70:71], v89 offset:33280
    s_waitcnt lgkmcnt(4)
    v_mfma_f32_32x32x16_bf16 v[32:47], v[80:83], v[128:131], 0
    ds_read_b64_tr_b16 v[72:73], v100 offset:36864
    ds_read_b64_tr_b16 v[74:75], v100 offset:37376
    ds_read_b64_tr_b16 v[76:77], v101 offset:36864
    s_mov_b32 exec_lo, 0x00030003
    s_mov_b32 exec_hi, 0x00030003
    ds_write_b128 v91, v[108:111] offset:0
    s_mov_b64 exec, -1
    s_waitcnt vmcnt(7)
    v_cmp_ne_u32 vcc, s56, v119
    s_cbranch_vccz L_GR_H_OK
    s_mov_b32 s6, 0
L_GR_H_RETRY:
    s_sleep 4
    buffer_load_dwordx2 v[118:119], v90, s[36:39], s21 offen sc1
    s_add_u32 s6, s6, 1
    s_cmp_gt_u32 s6, 0x8000
    s_waitcnt vmcnt(0)
    s_cbranch_scc1 L_GR_H_OK
    v_cmp_ne_u32 vcc, s56, v119
    s_cbranch_vccnz L_GR_H_RETRY
L_GR_H_OK:
    v_mfma_f32_32x32x16_bf16 v[48:63], v[84:87], v[128:131], 0
    ds_read_b64_tr_b16 v[78:79], v101 offset:37376
    v_mfma_f32_16x16x32_bf16 v[108:111], v[80:83], v[112:115], 0
    v_and_b32 v94, 0xffff0000, v118
    v_rcp_f32 v94, v94
    v_lshlrev_b32 v95, 16, v118
    v_mul_f32 v94, v94, v94
    s_waitcnt lgkmcnt(0)
    s_barrier
    v_mfma_f32_32x32x16_bf16 v[32:47], v[64:67], v[132:135], v[32:47]
    ds_read_b64_tr_b16 v[80:81], v88 offset:36864
    ds_read_b64_tr_b16 v[82:83], v88 offset:37376
    ds_read_b64_tr_b16 v[84:85], v89 offset:36864
    s_add_u32 m0, s3, 98304
    s_nop 0
    buffer_load_dwordx4 v104, s[28:31], s65 offen offset:0 lds
    buffer_load_dwordx4 v105, s[28:31], s65 offen offset:1024 lds
    s_add_u32 m0, s17, 131072
    s_add_u32 s19, s18, 65536
    buffer_load_dwordx4 v120, s[44:47], s19 offen lds
    buffer_load_dwordx4 v121, s[44:47], s19 offen offset:1024 lds
    v_mfma_f32_32x32x16_bf16 v[48:63], v[68:71], v[132:135], v[48:63]
    ds_read_b64_tr_b16 v[86:87], v89 offset:37376
    s_waitcnt lgkmcnt(4)
    v_mfma_f32_32x32x16_bf16 v[32:47], v[72:75], v[136:139], v[32:47]
    ds_read_b64_tr_b16 v[64:65], v100 offset:40960
    ds_read_b64_tr_b16 v[66:67], v100 offset:41472
    ds_read_b64_tr_b16 v[68:69], v101 offset:40960
    ds_read_b32 v131, v92 offset:0
    ds_read_b32 v130, v92 offset:512
    ds_read_b32 v135, v93 offset:0
    ds_read_b32 v134, v93 offset:512
    v_mfma_f32_32x32x16_bf16 v[48:63], v[76:79], v[136:139], v[48:63]
    ds_read_b64_tr_b16 v[70:71], v101 offset:41472
    v_mfma_f32_16x16x32_bf16 v[108:111], v[72:75], v[112:115], v[108:111]
    s_add_u32 m0, s17, 133120
    s_add_u32 s19, s18, 196608
    buffer_load_dwordx4 v120, s[44:47], s19 offen lds
    buffer_load_dwordx4 v121, s[44:47], s19 offen offset:1024 lds
    s_waitcnt lgkmcnt(4)
    v_mfma_f32_32x32x16_bf16 v[32:47], v[80:83], v[140:143], v[32:47]
    ds_read_b64_tr_b16 v[72:73], v88 offset:40960
    ds_read_b64_tr_b16 v[74:75], v88 offset:41472
    ds_read_b64_tr_b16 v[76:77], v89 offset:40960
    s_add_u32 m0, s3, 114688
    s_nop 0
    buffer_load_dwordx4 v104, s[32:35], s65 offen offset:0 lds
    buffer_load_dwordx4 v105, s[32:35], s65 offen offset:1024 lds
    s_add_u32 s65, s65, 458752
    v_mfma_f32_32x32x16_bf16 v[48:63], v[84:87], v[140:143], v[48:63]
    ds_read_b64_tr_b16 v[78:79], v89 offset:41472
    s_add_u32 m0, s17, 135168
    s_add_u32 s19, s18, 327680
    buffer_load_dwordx4 v120, s[44:47], s19 offen lds
    buffer_load_dwordx4 v121, s[44:47], s19 offen offset:1024 lds
    s_waitcnt lgkmcnt(4)
    v_mfma_f32_32x32x16_bf16 v[32:47], v[64:67], v[144:147], v[32:47]
    ds_read_b64_tr_b16 v[80:81], v100 offset:45056
    ds_read_b64_tr_b16 v[82:83], v100 offset:45568
    ds_read_b64_tr_b16 v[84:85], v101 offset:45056
    v_add_f32 v131, v131, v130
    v_cvt_pk_bf16_f32 v128, v131, v131
    v_lshlrev_b32 v130, 16, v128
    v_sub_f32 v131, v131, v130
    v_cvt_pk_bf16_f32 v128, v130, v131
    v_and_b32 v130, 0xffff0000, v128
    v_sub_f32 v131, v131, v130
    v_cvt_pk_bf16_f32 v129, v131, 0
    v_mov_b32 v130, 0
    v_mov_b32 v131, 0
    v_add_f32 v135, v135, v134
    v_cvt_pk_bf16_f32 v132, v135, v135
    v_lshlrev_b32 v134, 16, v132
    v_mfma_f32_32x32x16_bf16 v[48:63], v[68:71], v[144:147], v[48:63]
    ds_read_b64_tr_b16 v[86:87], v101 offset:45568
    v_mfma_f32_16x16x32_bf16 v[108:111], v[64:67], v[112:115], v[108:111]
    v_sub_f32 v135, v135, v134
    v_cvt_pk_bf16_f32 v132, v134, v135
    v_and_b32 v134, 0xffff0000, v132
    v_sub_f32 v135, v135, v134
    v_cvt_pk_bf16_f32 v133, v135, 0
    v_mov_b32 v134, 0
    v_mov_b32 v135, 0
    v_cmp_gt_u32 vcc, 32, v106
    v_cvt_pk_bf16_f32 v137, -v95, -v95
    s_nop 0
    v_cndmask_b32 v136, 0, v137, vcc
    v_mov_b32 v137, v136
    v_mov_b32 v138, 0
    v_mov_b32 v139, 0
    s_waitcnt lgkmcnt(4)
    v_mfma_f32_32x32x16_bf16 v[32:47], v[72:75], v[148:151], v[32:47]
    ds_read_b64_tr_b16 v[64:65], v88 offset:45056
    ds_read_b64_tr_b16 v[66:67], v88 offset:45568
    ds_read_b64_tr_b16 v[68:69], v89 offset:45056
    v_mfma_f32_32x32x16_bf16 v[0:15], v[128:131], v[136:139], v[0:15]
    v_mfma_f32_32x32x16_bf16 v[48:63], v[76:79], v[148:151], v[48:63]
    ds_read_b64_tr_b16 v[70:71], v89 offset:45568
    v_mfma_f32_32x32x16_bf16 v[16:31], v[132:135], v[136:139], v[16:31]
    s_waitcnt vmcnt(12) lgkmcnt(0)
    v_xor_b32 v100, 0x10000, v100
    v_xor_b32 v101, 0x10000, v101
    v_xor_b32 v88, 0x10000, v88
    v_xor_b32 v89, 0x10000, v89
    s_barrier
    v_mfma_f32_32x32x16_bf16 v[32:47], v[80:83], v[152:155], v[32:47]
    ds_read_b64_tr_b16 v[72:73], v100 offset:0
    ds_read_b64_tr_b16 v[74:75], v100 offset:512
    ds_read_b64_tr_b16 v[76:77], v101 offset:0
    v_mul_f32 v0, v0, v94
    v_mul_f32 v1, v1, v94
    v_mul_f32 v2, v2, v94
    v_mul_f32 v3, v3, v94
    v_mul_f32 v4, v4, v94
    v_mul_f32 v5, v5, v94
    v_mul_f32 v6, v6, v94
    v_mul_f32 v7, v7, v94
    v_mul_f32 v0, v0, v16
    v_mul_f32 v1, v1, v17
    v_mul_f32 v2, v2, v18
    v_mfma_f32_32x32x16_bf16 v[48:63], v[84:87], v[152:155], v[48:63]
    ds_read_b64_tr_b16 v[78:79], v101 offset:512
    v_mfma_f32_16x16x32_bf16 v[108:111], v[80:83], v[112:115], v[108:111]
    v_mul_f32 v3, v3, v19
    v_mul_f32 v4, v4, v20
    v_mul_f32 v5, v5, v21
    v_mul_f32 v6, v6, v22
    v_mul_f32 v7, v7, v23
    v_cvt_pk_bf16_f32 v16, v0, v1
    v_cvt_pk_bf16_f32 v17, v2, v3
    v_cvt_pk_bf16_f32 v18, v4, v5
    v_cvt_pk_bf16_f32 v19, v6, v7
    buffer_store_dwordx4 v[16:19], v107, s[36:39], s20 offen offset:0 sc1
    s_waitcnt lgkmcnt(4)
    v_mfma_f32_32x32x16_bf16 v[32:47], v[64:67], v[156:159], v[32:47]
    ds_read_b64_tr_b16 v[80:81], v88 offset:0
    ds_read_b64_tr_b16 v[82:83], v88 offset:512
    ds_read_b64_tr_b16 v[84:85], v89 offset:0
    s_waitcnt vmcnt(7)
    ds_read_b64_tr_b16 v[144:145], v124 offset:32768
    ds_read_b64_tr_b16 v[146:147], v124 offset:33792
    ds_read_b64_tr_b16 v[148:149], v125 offset:32768
    ds_read_b64_tr_b16 v[150:151], v125 offset:33792
    v_mul_f32 v8, v8, v94
    v_mul_f32 v9, v9, v94
    v_mul_f32 v10, v10, v94
    v_mul_f32 v11, v11, v94
    v_mul_f32 v12, v12, v94
    v_mul_f32 v13, v13, v94
    v_mul_f32 v14, v14, v94
    v_mul_f32 v15, v15, v94
    v_mfma_f32_32x32x16_bf16 v[48:63], v[68:71], v[156:159], v[48:63]
    ds_read_b64_tr_b16 v[86:87], v89 offset:512
    v_mul_f32 v8, v8, v24
    v_mul_f32 v9, v9, v25
    v_mul_f32 v10, v10, v26
    v_mul_f32 v11, v11, v27
    v_mul_f32 v12, v12, v28
    v_mul_f32 v13, v13, v29
    v_mul_f32 v14, v14, v30
    v_mul_f32 v15, v15, v31
    v_cvt_pk_bf16_f32 v24, v8, v9
    v_cvt_pk_bf16_f32 v25, v10, v11
    v_cvt_pk_bf16_f32 v26, v12, v13
    v_cvt_pk_bf16_f32 v27, v14, v15
    buffer_store_dwordx4 v[24:27], v107, s[36:39], s20 offen offset:1024 sc1
    s_waitcnt lgkmcnt(4)
    v_mfma_f32_32x32x16_bf16 v[32:47], v[72:75], v[160:163], v[32:47]
    ds_read_b64_tr_b16 v[64:65], v100 offset:4096
    ds_read_b64_tr_b16 v[66:67], v100 offset:4608
    ds_read_b64_tr_b16 v[68:69], v101 offset:4096
    s_add_u32 m0, s3, 0
    s_nop 0
    buffer_load_dwordx4 v104, s[28:31], s65 offen offset:0 lds
    buffer_load_dwordx4 v105, s[28:31], s65 offen offset:1024 lds
    v_mfma_f32_32x32x16_bf16 v[48:63], v[76:79], v[160:163], v[48:63]
    ds_read_b64_tr_b16 v[70:71], v101 offset:4608
    v_mfma_f32_16x16x32_bf16 v[108:111], v[72:75], v[112:115], v[108:111]
    s_waitcnt lgkmcnt(4)
    v_mfma_f32_32x32x16_bf16 v[32:47], v[80:83], v[164:167], v[32:47]
    ds_read_b64_tr_b16 v[72:73], v88 offset:4096
    ds_read_b64_tr_b16 v[74:75], v88 offset:4608
    ds_read_b64_tr_b16 v[76:77], v89 offset:4096
    s_waitcnt vmcnt(8)
    ds_read_b64_tr_b16 v[152:153], v124 offset:34816
    ds_read_b64_tr_b16 v[154:155], v124 offset:35840
    v_mfma_f32_32x32x16_bf16 v[48:63], v[84:87], v[164:167], v[48:63]
    ds_read_b64_tr_b16 v[78:79], v89 offset:4608
    ds_read_b64_tr_b16 v[156:157], v125 offset:34816
    ds_read_b64_tr_b16 v[158:159], v125 offset:35840
    s_waitcnt lgkmcnt(4)
    v_mfma_f32_32x32x16_bf16 v[32:47], v[64:67], v[168:171], v[32:47]
    ds_read_b64_tr_b16 v[80:81], v100 offset:8192
    ds_read_b64_tr_b16 v[82:83], v100 offset:8704
    ds_read_b64_tr_b16 v[84:85], v101 offset:8192
    s_add_u32 m0, s3, 16384
    s_nop 0
    buffer_load_dwordx4 v104, s[32:35], s65 offen offset:0 lds
    buffer_load_dwordx4 v105, s[32:35], s65 offen offset:1024 lds
    s_add_u32 s65, s65, 458752
    v_mfma_f32_32x32x16_bf16 v[48:63], v[68:71], v[168:171], v[48:63]
    ds_read_b64_tr_b16 v[86:87], v101 offset:8704
    v_mfma_f32_16x16x32_bf16 v[108:111], v[64:67], v[112:115], v[108:111]
    s_add_u32 m0, s17, 32768
    s_add_u32 s19, s18, 786432
    buffer_load_dwordx4 v120, s[44:47], s19 offen lds
    buffer_load_dwordx4 v121, s[44:47], s19 offen offset:1024 lds
    s_waitcnt lgkmcnt(4)
    v_mfma_f32_32x32x16_bf16 v[32:47], v[72:75], v[172:175], v[32:47]
    ds_read_b64_tr_b16 v[64:65], v88 offset:8192
    ds_read_b64_tr_b16 v[66:67], v88 offset:8704
    ds_read_b64_tr_b16 v[68:69], v89 offset:8192
    s_waitcnt vmcnt(8)
    ds_read_b64_tr_b16 v[160:161], v124 offset:36864
    ds_read_b64_tr_b16 v[162:163], v124 offset:37888
    ds_read_b64_tr_b16 v[164:165], v125 offset:36864
    ds_read_b64_tr_b16 v[166:167], v125 offset:37888
    s_add_u32 m0, s17, 34816
    s_add_u32 s19, s18, 917504
    buffer_load_dwordx4 v120, s[44:47], s19 offen lds
    buffer_load_dwordx4 v121, s[44:47], s19 offen offset:1024 lds
    v_mfma_f32_32x32x16_bf16 v[48:63], v[76:79], v[172:175], v[48:63]
    ds_read_b64_tr_b16 v[70:71], v89 offset:8704
    v_lshrrev_b32 v116, 2, v106
    v_lshlrev_b32 v116, 10, v116
    v_and_b32 v117, 3, v106
    v_lshl_add_u32 v116, v117, 4, v116
    s_add_u32 m0, s17, 131072
    s_add_u32 s7, s12, 15360
    buffer_load_dwordx4 v116, s[24:27], s12 offen lds
    buffer_load_dwordx4 v116, s[24:27], s7 offen offset:1024 lds
    s_waitcnt lgkmcnt(4)
    v_mfma_f32_32x32x16_bf16 v[32:47], v[80:83], v[176:179], v[32:47]
    ds_read_b64_tr_b16 v[72:73], v100 offset:12288
    ds_read_b64_tr_b16 v[74:75], v100 offset:12800
    ds_read_b64_tr_b16 v[76:77], v101 offset:12288
    s_lshl_b32 s5, s59, 1
    s_lshr_b32 s4, s58, 1
    s_add_u32 s5, s5, s4
    s_lshl_b32 s5, s5, 13
    s_lshl_b32 s4, s60, 8
    s_add_u32 s5, s5, s4
    s_and_b32 s4, s58, 1
    v_mfma_f32_32x32x16_bf16 v[48:63], v[84:87], v[176:179], v[48:63]
    ds_read_b64_tr_b16 v[78:79], v101 offset:12800
    v_mfma_f32_16x16x32_bf16 v[108:111], v[80:83], v[112:115], v[108:111]
    s_lshl_b32 s4, s4, 7
    s_add_u32 s5, s5, s4
    s_add_u32 s5, s5, 0x80000
    s_add_u32 m0, s17, 36864
    s_add_u32 s19, s18, 1048576
    buffer_load_dwordx4 v120, s[44:47], s19 offen lds
    buffer_load_dwordx4 v121, s[44:47], s19 offen offset:1024 lds
    s_waitcnt lgkmcnt(4)
    v_mfma_f32_32x32x16_bf16 v[32:47], v[64:67], v[180:183], v[32:47]
    ds_read_b64_tr_b16 v[80:81], v88 offset:12288
    ds_read_b64_tr_b16 v[82:83], v88 offset:12800
    ds_read_b64_tr_b16 v[84:85], v89 offset:12288
    s_add_u32 m0, s17, 38912
    s_add_u32 s19, s18, 1179648
    buffer_load_dwordx4 v120, s[44:47], s19 offen lds
    buffer_load_dwordx4 v121, s[44:47], s19 offen offset:1024 lds
    v_mfma_f32_32x32x16_bf16 v[48:63], v[68:71], v[180:183], v[48:63]
    ds_read_b64_tr_b16 v[86:87], v89 offset:12800
    s_waitcnt vmcnt(14) lgkmcnt(0)
    s_barrier
    v_mfma_f32_32x32x16_bf16 v[32:47], v[72:75], v[184:187], v[32:47]
    ds_read_b64_tr_b16 v[64:65], v100 offset:32768
    ds_read_b64_tr_b16 v[66:67], v100 offset:33280
    ds_read_b64_tr_b16 v[68:69], v101 offset:32768
    v_mfma_f32_32x32x16_bf16 v[48:63], v[76:79], v[184:187], v[48:63]
    ds_read_b64_tr_b16 v[70:71], v101 offset:33280
    v_mfma_f32_16x16x32_bf16 v[108:111], v[72:75], v[112:115], v[108:111]
    s_waitcnt lgkmcnt(4)
    v_mfma_f32_32x32x16_bf16 v[32:47], v[80:83], v[188:191], v[32:47]
    ds_read_b64_tr_b16 v[72:73], v88 offset:32768
    ds_read_b64_tr_b16 v[74:75], v88 offset:33280
    ds_read_b64_tr_b16 v[76:77], v89 offset:32768
    s_add_u32 m0, s17, 65536
    s_add_u32 s19, s18, 1310720
    buffer_load_dwordx4 v120, s[44:47], s19 offen lds
    buffer_load_dwordx4 v121, s[44:47], s19 offen offset:1024 lds
    v_mfma_f32_32x32x16_bf16 v[48:63], v[84:87], v[188:191], v[48:63]
    ds_read_b64_tr_b16 v[78:79], v89 offset:33280
    s_waitcnt lgkmcnt(4)
    v_mfma_f32_32x32x16_bf16 v[32:47], v[64:67], v[192:195], v[32:47]
    ds_read_b64_tr_b16 v[80:81], v100 offset:36864
    ds_read_b64_tr_b16 v[82:83], v100 offset:37376
    ds_read_b64_tr_b16 v[84:85], v101 offset:36864
    s_add_u32 m0, s17, 67584
    s_add_u32 s19, s18, 1441792
    buffer_load_dwordx4 v120, s[44:47], s19 offen lds
    buffer_load_dwordx4 v121, s[44:47], s19 offen offset:1024 lds
    v_and_b32 v116, 31, v106
    v_lshlrev_b32 v116, 6, v116
    v_lshrrev_b32 v117, 5, v106
    v_lshl_add_u32 v116, v117, 3, v116
    s_add_u32 s7, s17, 131072
    v_add_u32 v116, s7, v116
    v_mfma_f32_32x32x16_bf16 v[48:63], v[68:71], v[192:195], v[48:63]
    ds_read_b64_tr_b16 v[86:87], v101 offset:37376
    v_mfma_f32_16x16x32_bf16 v[108:111], v[64:67], v[112:115], v[108:111]
    s_waitcnt vmcnt(8)
    ds_read_b64 v[16:17], v116 offset:0
    ds_read_b64 v[18:19], v116 offset:16
    ds_read_b64 v[20:21], v116 offset:32
    ds_read_b64 v[22:23], v116 offset:48
    s_waitcnt lgkmcnt(4)
    v_mfma_f32_32x32x16_bf16 v[32:47], v[72:75], v[196:199], v[32:47]
    ds_read_b64_tr_b16 v[64:65], v88 offset:36864
    ds_read_b64_tr_b16 v[66:67], v88 offset:37376
    ds_read_b64_tr_b16 v[68:69], v89 offset:36864
    s_add_u32 m0, s17, 69632
    s_add_u32 s19, s18, 1572864
    buffer_load_dwordx4 v120, s[44:47], s19 offen lds
    buffer_load_dwordx4 v121, s[44:47], s19 offen offset:1024 lds
    v_mfma_f32_32x32x16_bf16 v[48:63], v[76:79], v[196:199], v[48:63]
    ds_read_b64_tr_b16 v[70:71], v89 offset:37376
    s_waitcnt lgkmcnt(4)
    v_mfma_f32_32x32x16_bf16 v[32:47], v[80:83], v[200:203], v[32:47]
    ds_read_b64_tr_b16 v[72:73], v100 offset:40960
    ds_read_b64_tr_b16 v[74:75], v100 offset:41472
    ds_read_b64_tr_b16 v[76:77], v101 offset:40960
    s_add_u32 m0, s17, 71680
    s_add_u32 s19, s18, 1703936
    buffer_load_dwordx4 v120, s[44:47], s19 offen lds
    buffer_load_dwordx4 v121, s[44:47], s19 offen offset:1024 lds
    v_lshlrev_b32 v0, 16, v16
    v_mfma_f32_32x32x16_bf16 v[48:63], v[84:87], v[200:203], v[48:63]
    ds_read_b64_tr_b16 v[78:79], v101 offset:41472
    v_mfma_f32_16x16x32_bf16 v[108:111], v[80:83], v[112:115], v[108:111]
    v_and_b32 v1, 0xffff0000, v16
    v_lshlrev_b32 v2, 16, v17
    v_and_b32 v3, 0xffff0000, v17
    v_lshlrev_b32 v4, 16, v18
    v_and_b32 v5, 0xffff0000, v18
    s_waitcnt lgkmcnt(4)
    v_mfma_f32_32x32x16_bf16 v[32:47], v[64:67], v[204:207], v[32:47]
    ds_read_b64_tr_b16 v[80:81], v88 offset:40960
    ds_read_b64_tr_b16 v[82:83], v88 offset:41472
    ds_read_b64_tr_b16 v[84:85], v89 offset:40960
    s_add_u32 m0, s17, 131072
    s_add_u32 s19, s18, 393216
    buffer_load_dwordx4 v120, s[44:47], s19 offen lds
    buffer_load_dwordx4 v121, s[44:47], s19 offen offset:1024 lds
    v_lshlrev_b32 v6, 16, v19
    v_mfma_f32_32x32x16_bf16 v[48:63], v[68:71], v[204:207], v[48:63]
    ds_read_b64_tr_b16 v[86:87], v89 offset:41472
    v_and_b32 v7, 0xffff0000, v19
    v_lshlrev_b32 v8, 16, v20
    v_and_b32 v9, 0xffff0000, v20
    v_lshlrev_b32 v10, 16, v21
    s_waitcnt lgkmcnt(4)
    v_mfma_f32_32x32x16_bf16 v[32:47], v[72:75], v[208:211], v[32:47]
    ds_read_b64_tr_b16 v[64:65], v100 offset:45056
    ds_read_b64_tr_b16 v[66:67], v100 offset:45568
    ds_read_b64_tr_b16 v[68:69], v101 offset:45056
    s_add_u32 m0, s17, 133120
    s_add_u32 s19, s18, 524288
    buffer_load_dwordx4 v120, s[44:47], s19 offen lds
    buffer_load_dwordx4 v121, s[44:47], s19 offen offset:1024 lds
    v_and_b32 v11, 0xffff0000, v21
    v_mfma_f32_32x32x16_bf16 v[48:63], v[76:79], v[208:211], v[48:63]
    ds_read_b64_tr_b16 v[70:71], v101 offset:45568
    v_mfma_f32_16x16x32_bf16 v[108:111], v[72:75], v[112:115], v[108:111]
    v_lshlrev_b32 v12, 16, v22
    v_and_b32 v13, 0xffff0000, v22
    v_lshlrev_b32 v14, 16, v23
    v_and_b32 v15, 0xffff0000, v23
    s_waitcnt lgkmcnt(4)
    v_mfma_f32_32x32x16_bf16 v[32:47], v[80:83], v[212:215], v[32:47]
    ds_read_b64_tr_b16 v[72:73], v88 offset:45056
    ds_read_b64_tr_b16 v[74:75], v88 offset:45568
    ds_read_b64_tr_b16 v[76:77], v89 offset:45056
    s_add_u32 m0, s17, 135168
    s_add_u32 s19, s18, 655360
    buffer_load_dwordx4 v120, s[44:47], s19 offen lds
    buffer_load_dwordx4 v121, s[44:47], s19 offen offset:1024 lds
    v_mfma_f32_32x32x16_bf16 v[48:63], v[84:87], v[212:215], v[48:63]
    ds_read_b64_tr_b16 v[78:79], v89 offset:45568
    s_waitcnt lgkmcnt(0)
    v_xor_b32 v100, 0x10000, v100
    v_xor_b32 v101, 0x10000, v101
    v_xor_b32 v88, 0x10000, v88
    v_xor_b32 v89, 0x10000, v89
    s_barrier
    v_mfma_f32_32x32x16_bf16 v[32:47], v[64:67], v[216:219], v[32:47]
    ds_read_b64_tr_b16 v[80:81], v100 offset:0
    ds_read_b64_tr_b16 v[82:83], v100 offset:512
    ds_read_b64_tr_b16 v[84:85], v101 offset:0
    s_add_u32 m0, s17, 98304
    s_add_u32 s19, s18, 0
    buffer_load_dwordx4 v120, s[44:47], s19 offen lds
    buffer_load_dwordx4 v121, s[44:47], s19 offen offset:1024 lds
    v_mfma_f32_32x32x16_bf16 v[48:63], v[68:71], v[216:219], v[48:63]
    ds_read_b64_tr_b16 v[86:87], v101 offset:512
    v_mfma_f32_16x16x32_bf16 v[108:111], v[64:67], v[112:115], v[108:111]
    s_waitcnt lgkmcnt(4)
    v_mfma_f32_32x32x16_bf16 v[32:47], v[72:75], v[220:223], v[32:47]
    ds_read_b64_tr_b16 v[64:65], v88 offset:0
    ds_read_b64_tr_b16 v[66:67], v88 offset:512
    ds_read_b64_tr_b16 v[68:69], v89 offset:0
    s_add_u32 m0, s17, 100352
    s_add_u32 s19, s18, 131072
    buffer_load_dwordx4 v120, s[44:47], s19 offen lds
    buffer_load_dwordx4 v121, s[44:47], s19 offen offset:1024 lds
    v_mfma_f32_32x32x16_bf16 v[48:63], v[76:79], v[220:223], v[48:63]
    ds_read_b64_tr_b16 v[70:71], v89 offset:512
    s_waitcnt lgkmcnt(4)
    v_mfma_f32_32x32x16_bf16 v[32:47], v[80:83], v[224:227], v[32:47]
    ds_read_b64_tr_b16 v[72:73], v100 offset:4096
    ds_read_b64_tr_b16 v[74:75], v100 offset:4608
    ds_read_b64_tr_b16 v[76:77], v101 offset:4096
    s_add_u32 m0, s17, 102400
    s_add_u32 s19, s18, 262144
    buffer_load_dwordx4 v120, s[44:47], s19 offen lds
    buffer_load_dwordx4 v121, s[44:47], s19 offen offset:1024 lds
    v_mfma_f32_32x32x16_bf16 v[48:63], v[84:87], v[224:227], v[48:63]
    ds_read_b64_tr_b16 v[78:79], v101 offset:4608
    v_mfma_f32_16x16x32_bf16 v[108:111], v[80:83], v[112:115], v[108:111]
    buffer_load_dword v127, v126, s[36:39], s9 offen sc1
    s_waitcnt lgkmcnt(4)
    v_mfma_f32_32x32x16_bf16 v[32:47], v[64:67], v[228:231], v[32:47]
    ds_read_b64_tr_b16 v[80:81], v88 offset:4096
    ds_read_b64_tr_b16 v[82:83], v88 offset:4608
    ds_read_b64_tr_b16 v[84:85], v89 offset:4096
    v_mfma_f32_32x32x16_bf16 v[48:63], v[68:71], v[228:231], v[48:63]
    ds_read_b64_tr_b16 v[86:87], v89 offset:4608
    s_waitcnt lgkmcnt(4)
    v_mfma_f32_32x32x16_bf16 v[32:47], v[72:75], v[232:235], v[32:47]
    ds_read_b64_tr_b16 v[64:65], v100 offset:8192
    ds_read_b64_tr_b16 v[66:67], v100 offset:8704
    ds_read_b64_tr_b16 v[68:69], v101 offset:8192
    v_mfma_f32_32x32x16_bf16 v[48:63], v[76:79], v[232:235], v[48:63]
    ds_read_b64_tr_b16 v[70:71], v101 offset:8704
    v_mfma_f32_16x16x32_bf16 v[108:111], v[72:75], v[112:115], v[108:111]
    s_waitcnt lgkmcnt(4)
    v_mfma_f32_32x32x16_bf16 v[32:47], v[80:83], v[236:239], v[32:47]
    ds_read_b64_tr_b16 v[72:73], v88 offset:8192
    ds_read_b64_tr_b16 v[74:75], v88 offset:8704
    ds_read_b64_tr_b16 v[76:77], v89 offset:8192
    v_mfma_f32_32x32x16_bf16 v[48:63], v[84:87], v[236:239], v[48:63]
    ds_read_b64_tr_b16 v[78:79], v89 offset:8704
    s_waitcnt lgkmcnt(4)
    v_mfma_f32_32x32x16_bf16 v[32:47], v[64:67], v[240:243], v[32:47]
    ds_read_b64_tr_b16 v[80:81], v100 offset:12288
    ds_read_b64_tr_b16 v[82:83], v100 offset:12800
    ds_read_b64_tr_b16 v[84:85], v101 offset:12288
    s_waitcnt vmcnt(0)
    v_cmp_ne_u32 vcc, s56, v127
    s_nop 0
    s_and_b32 s66, vcc_lo, 0x3fff
    s_add_u32 s7, s10, 0
    buffer_load_dwordx4 v[168:171], v107, s[36:39], s7 offen sc1
    v_mfma_f32_32x32x16_bf16 v[48:63], v[68:71], v[240:243], v[48:63]
    ds_read_b64_tr_b16 v[86:87], v101 offset:12800
    v_mfma_f32_16x16x32_bf16 v[108:111], v[64:67], v[112:115], v[108:111]
    s_add_u32 s7, s11, 0
    buffer_load_dwordx4 v[172:175], v107, s[36:39], s7 offen sc1
    s_add_u32 s7, s10, 8192
    buffer_load_dwordx4 v[176:179], v107, s[36:39], s7 offen sc1
    s_waitcnt lgkmcnt(4)
    v_mfma_f32_32x32x16_bf16 v[32:47], v[72:75], v[244:247], v[32:47]
    ds_read_b64_tr_b16 v[64:65], v88 offset:12288
    ds_read_b64_tr_b16 v[66:67], v88 offset:12800
    ds_read_b64_tr_b16 v[68:69], v89 offset:12288
    s_add_u32 s7, s11, 8192
    buffer_load_dwordx4 v[180:183], v107, s[36:39], s7 offen sc1
    s_add_u32 s7, s10, 16384
    buffer_load_dwordx4 v[184:187], v107, s[36:39], s7 offen sc1
    v_mfma_f32_32x32x16_bf16 v[48:63], v[76:79], v[244:247], v[48:63]
    ds_read_b64_tr_b16 v[70:71], v89 offset:12800
    s_add_u32 s7, s11, 16384
    buffer_load_dwordx4 v[188:191], v107, s[36:39], s7 offen sc1
    s_waitcnt lgkmcnt(4)
    v_mfma_f32_32x32x16_bf16 v[32:47], v[80:83], v[248:251], v[32:47]
    s_add_u32 s7, s10, 24576
    buffer_load_dwordx4 v[192:195], v107, s[36:39], s7 offen sc1
    s_add_u32 s7, s11, 24576
    buffer_load_dwordx4 v[196:199], v107, s[36:39], s7 offen sc1
    v_mfma_f32_32x32x16_bf16 v[48:63], v[84:87], v[248:251], v[48:63]
    v_mfma_f32_16x16x32_bf16 v[108:111], v[80:83], v[112:115], v[108:111]
    s_add_u32 s7, s10, 32768
    buffer_load_dwordx4 v[200:203], v107, s[36:39], s7 offen sc1
    s_waitcnt lgkmcnt(0)
    v_mfma_f32_32x32x16_bf16 v[32:47], v[64:67], v[252:255], v[32:47]
    s_add_u32 s7, s11, 32768
    buffer_load_dwordx4 v[204:207], v107, s[36:39], s7 offen sc1
    s_add_u32 s7, s10, 40960
    buffer_load_dwordx4 v[208:211], v107, s[36:39], s7 offen sc1
    v_mfma_f32_32x32x16_bf16 v[48:63], v[68:71], v[252:255], v[48:63]
    s_add_u32 s7, s11, 40960
    buffer_load_dwordx4 v[212:215], v107, s[36:39], s7 offen sc1
    s_mov_b32 exec_lo, 0x00030003
    s_mov_b32 exec_hi, 0x00030003
    ds_write_b128 v91, v[108:111] offset:1024
    s_mov_b64 exec, -1
    v_mov_b32 v104, 162816
    v_mov_b32 v105, 1
    s_mov_b64 exec, 1
    ds_add_u32 v104, v105 offset:12
    s_mov_b64 exec, -1
    s_mov_b32 s6, 0
L_LW_B0:
    ds_read_b32 v116, v104 offset:12
    s_add_u32 s6, s6, 1
    s_waitcnt lgkmcnt(0)
    v_readfirstlane_b32 s7, v116
    s_cmp_gt_u32 s6, 0x40000
    s_cbranch_scc1 L_LWD_B0
    s_cmp_ge_u32 s7, 4
    s_cbranch_scc1 L_LWD_B0
    s_branch L_LW_B0
L_LWD_B0:
    ds_read_b32 v67, v92 offset:1024
    ds_read_b32 v66, v92 offset:1536
    ds_read_b32 v71, v93 offset:1024
    ds_read_b32 v70, v93 offset:1536
    s_waitcnt lgkmcnt(0)
    v_add_f32 v67, v67, v66
    v_cvt_pk_bf16_f32 v64, v67, v67
    v_lshlrev_b32 v66, 16, v64
    v_sub_f32 v67, v67, v66
    v_cvt_pk_bf16_f32 v64, v66, v67
    v_and_b32 v66, 0xffff0000, v64
    v_sub_f32 v67, v67, v66
    v_cvt_pk_bf16_f32 v65, v67, 0
    v_mov_b32 v66, 0
    v_mov_b32 v67, 0
    v_add_f32 v71, v71, v70
    v_cvt_pk_bf16_f32 v68, v71, v71
    v_lshlrev_b32 v70, 16, v68
    v_sub_f32 v71, v71, v70
    v_cvt_pk_bf16_f32 v68, v70, v71
    v_and_b32 v70, 0xffff0000, v68
    v_sub_f32 v71, v71, v70
    v_cvt_pk_bf16_f32 v69, v71, 0
    v_mov_b32 v70, 0
    v_mov_b32 v71, 0
    v_cmp_gt_u32 vcc, 32, v106
    v_cvt_pk_bf16_f32 v73, -v95, -v95
    s_nop 0
    v_cndmask_b32 v72, 0, v73, vcc
    v_mov_b32 v73, v72
    v_mov_b32 v74, 0
    v_mov_b32 v75, 0
    s_nop 1
    v_mfma_f32_32x32x16_bf16 v[32:47], v[64:67], v[72:75], v[32:47]
    v_mfma_f32_32x32x16_bf16 v[48:63], v[68:71], v[72:75], v[48:63]
    s_nop 10
    v_mul_f32 v32, v32, v94
    v_mul_f32 v33, v33, v94
    v_mul_f32 v34, v34, v94
    v_mul_f32 v35, v35, v94
    v_mul_f32 v36, v36, v94
    v_mul_f32 v37, v37, v94
    v_mul_f32 v38, v38, v94
    v_mul_f32 v39, v39, v94
    v_mul_f32 v32, v32, v48
    v_mul_f32 v33, v33, v49
    v_mul_f32 v34, v34, v50
    v_mul_f32 v35, v35, v51
    v_mul_f32 v36, v36, v52
    v_mul_f32 v37, v37, v53
    v_mul_f32 v38, v38, v54
    v_mul_f32 v39, v39, v55
    v_cvt_pk_bf16_f32 v48, v32, v33
    v_cvt_pk_bf16_f32 v49, v34, v35
    v_cvt_pk_bf16_f32 v50, v36, v37
    v_cvt_pk_bf16_f32 v51, v38, v39
    s_add_u32 s20, s20, 4096
    buffer_store_dwordx4 v[48:51], v107, s[36:39], s20 offen offset:0 sc1
    v_mul_f32 v40, v40, v94
    v_mul_f32 v41, v41, v94
    v_mul_f32 v42, v42, v94
    v_mul_f32 v43, v43, v94
    v_mul_f32 v44, v44, v94
    v_mul_f32 v45, v45, v94
    v_mul_f32 v46, v46, v94
    v_mul_f32 v47, v47, v94
    v_mul_f32 v40, v40, v56
    v_mul_f32 v41, v41, v57
    v_mul_f32 v42, v42, v58
    v_mul_f32 v43, v43, v59
    v_mul_f32 v44, v44, v60
    v_mul_f32 v45, v45, v61
    v_mul_f32 v46, v46, v62
    v_mul_f32 v47, v47, v63
    v_cvt_pk_bf16_f32 v56, v40, v41
    v_cvt_pk_bf16_f32 v57, v42, v43
    v_cvt_pk_bf16_f32 v58, v44, v45
    v_cvt_pk_bf16_f32 v59, v46, v47
    buffer_store_dwordx4 v[56:59], v107, s[36:39], s20 offen offset:1024 sc1
    s_branch L_P2_H
L_GU_F:
    s_setprio 1
    ds_read_b128 v[128:131], v96 offset:32768
    ds_read_b64_tr_b16 v[64:65], v100 offset:49152
    ds_read_b64_tr_b16 v[66:67], v100 offset:49664
    ds_read_b64_tr_b16 v[68:69], v101 offset:49152
    ds_read_b64_tr_b16 v[70:71], v101 offset:49664
    ds_read_b128 v[132:135], v97 offset:32768
    ds_read_b64_tr_b16 v[72:73], v88 offset:49152
    ds_read_b64_tr_b16 v[74:75], v88 offset:49664
    ds_read_b64_tr_b16 v[76:77], v89 offset:49152
    ds_read_b64_tr_b16 v[78:79], v89 offset:49664
    s_waitcnt lgkmcnt(5)
    v_mfma_f32_32x32x16_bf16 v[0:15], v[64:67], v[128:131], 0
    ds_read_b128 v[136:139], v98 offset:32768
    ds_read_b64_tr_b16 v[80:81], v100 offset:53248
    ds_read_b64_tr_b16 v[82:83], v100 offset:53760
    s_add_u32 m0, s69, 16384
    s_nop 0
    buffer_load_dwordx4 v104, s[28:31], s65 offen lds
    s_add_u32 m0, s69, 24576
    s_nop 0
    buffer_load_dwordx4 v104, s[32:35], s65 offen lds
    v_mfma_f32_32x32x16_bf16 v[16:31], v[68:71], v[128:131], 0
    ds_read_b64_tr_b16 v[84:85], v101 offset:53248
    ds_read_b64_tr_b16 v[86:87], v101 offset:53760
    v_mfma_f32_16x16x32_bf16 v[108:111], v[64:67], v[112:115], v[108:111]
    s_waitcnt lgkmcnt(5)
    v_mfma_f32_32x32x16_bf16 v[0:15], v[72:75], v[132:135], v[0:15]
    ds_read_b128 v[140:143], v99 offset:32768
    ds_read_b64_tr_b16 v[64:65], v88 offset:53248
    ds_read_b64_tr_b16 v[66:67], v88 offset:53760
    v_mfma_f32_32x32x16_bf16 v[16:31], v[76:79], v[132:135], v[16:31]
    ds_read_b64_tr_b16 v[68:69], v89 offset:53248
    ds_read_b64_tr_b16 v[70:71], v89 offset:53760
    s_waitcnt vmcnt(7) lgkmcnt(5)
    v_xor_b32 v100, 0x10000, v100
    v_xor_b32 v101, 0x10000, v101
    v_xor_b32 v88, 0x10000, v88
    v_xor_b32 v89, 0x10000, v89
    v_xor_b32 v96, 0x10000, v96
    v_xor_b32 v97, 0x10000, v97
    v_xor_b32 v98, 0x10000, v98
    v_xor_b32 v99, 0x10000, v99
    s_barrier
    v_mfma_f32_32x32x16_bf16 v[0:15], v[80:83], v[136:139], v[0:15]
    ds_read_b128 v[144:147], v96 offset:0
    ds_read_b64_tr_b16 v[72:73], v100 offset:16384
    ds_read_b64_tr_b16 v[74:75], v100 offset:16896
    s_add_u32 m0, s3, 0
    s_nop 0
    buffer_load_dwordx4 v102, s[24:27], s64 offen offset:0 lds
    buffer_load_dwordx4 v103, s[24:27], s64 offen offset:1024 lds
    s_add_i32 s64, s64, 128
    s_add_i32 s65, s65, 229376
    v_mfma_f32_32x32x16_bf16 v[16:31], v[84:87], v[136:139], v[16:31]
    ds_read_b64_tr_b16 v[76:77], v101 offset:16384
    ds_read_b64_tr_b16 v[78:79], v101 offset:16896
    v_mfma_f32_16x16x32_bf16 v[108:111], v[80:83], v[112:115], v[108:111]
    s_waitcnt lgkmcnt(5)
    v_mfma_f32_32x32x16_bf16 v[0:15], v[64:67], v[140:143], v[0:15]
    ds_read_b128 v[148:151], v97 offset:0
    ds_read_b64_tr_b16 v[80:81], v88 offset:16384
    ds_read_b64_tr_b16 v[82:83], v88 offset:16896
    v_mfma_f32_32x32x16_bf16 v[16:31], v[68:71], v[140:143], v[16:31]
    ds_read_b64_tr_b16 v[84:85], v89 offset:16384
    ds_read_b64_tr_b16 v[86:87], v89 offset:16896
    s_waitcnt lgkmcnt(5)
    v_mfma_f32_32x32x16_bf16 v[0:15], v[72:75], v[144:147], v[0:15]
    ds_read_b128 v[152:155], v98 offset:0
    ds_read_b64_tr_b16 v[64:65], v100 offset:20480
    ds_read_b64_tr_b16 v[66:67], v100 offset:20992
    v_mfma_f32_32x32x16_bf16 v[16:31], v[76:79], v[144:147], v[16:31]
    ds_read_b64_tr_b16 v[68:69], v101 offset:20480
    ds_read_b64_tr_b16 v[70:71], v101 offset:20992
    v_mfma_f32_16x16x32_bf16 v[108:111], v[72:75], v[112:115], v[108:111]
    s_waitcnt lgkmcnt(5)
    v_mfma_f32_32x32x16_bf16 v[0:15], v[80:83], v[148:151], v[0:15]
    ds_read_b128 v[156:159], v99 offset:0
    ds_read_b64_tr_b16 v[72:73], v88 offset:20480
    ds_read_b64_tr_b16 v[74:75], v88 offset:20992
    s_add_u32 m0, s11, 131072
    s_nop 0
    buffer_load_dwordx4 v36, s[52:55], s10 offen nt lds
    v_mfma_f32_32x32x16_bf16 v[16:31], v[84:87], v[148:151], v[16:31]
    ds_read_b64_tr_b16 v[76:77], v89 offset:20480
    ds_read_b64_tr_b16 v[78:79], v89 offset:20992
    s_mov_b32 m0, s18
    s_nop 0
    buffer_load_dwordx4 v44, s[20:23], s16 offen nt lds
    s_waitcnt vmcnt(6) lgkmcnt(5)
    s_barrier
    v_mfma_f32_32x32x16_bf16 v[0:15], v[64:67], v[152:155], v[0:15]
    ds_read_b128 v[160:163], v96 offset:32768
    ds_read_b64_tr_b16 v[80:81], v100 offset:49152
    ds_read_b64_tr_b16 v[82:83], v100 offset:49664
    s_add_u32 m0, s69, 49152
    s_nop 0
    buffer_load_dwordx4 v104, s[28:31], s65 offen lds
    s_add_u32 m0, s69, 57344
    s_nop 0
    buffer_load_dwordx4 v104, s[32:35], s65 offen lds
    v_lshrrev_b32 v116, 4, v106
    v_lshlrev_b32 v37, 10, v116
    v_mfma_f32_32x32x16_bf16 v[16:31], v[68:71], v[152:155], v[16:31]
    ds_read_b64_tr_b16 v[84:85], v101 offset:49152
    ds_read_b64_tr_b16 v[86:87], v101 offset:49664
    v_mfma_f32_16x16x32_bf16 v[108:111], v[64:67], v[112:115], v[108:111]
    v_bfe_u32 v117, v106, 2, 2
    v_lshl_add_u32 v37, v117, 7, v37
    v_bfe_u32 v118, v106, 1, 1
    s_lshl_b32 s11, s58, 1
    v_add_u32 v118, s11, v118
    s_waitcnt lgkmcnt(5)
    v_mfma_f32_32x32x16_bf16 v[0:15], v[72:75], v[156:159], v[0:15]
    ds_read_b128 v[164:167], v97 offset:32768
    ds_read_b64_tr_b16 v[64:65], v88 offset:49152
    ds_read_b64_tr_b16 v[66:67], v88 offset:49664
    v_xor_b32 v118, v118, v117
    v_lshl_add_u32 v37, v118, 4, v37
    v_and_b32 v118, 1, v106
    v_mfma_f32_32x32x16_bf16 v[16:31], v[76:79], v[156:159], v[16:31]
    ds_read_b64_tr_b16 v[68:69], v89 offset:49152
    ds_read_b64_tr_b16 v[70:71], v89 offset:49664
    v_lshl_add_u32 v37, v118, 3, v37
    s_lshr_b32 s8, s57, 2
    s_lshl_b32 s11, s8, 12
    s_waitcnt lgkmcnt(5)
    v_mfma_f32_32x32x16_bf16 v[0:15], v[80:83], v[160:163], v[0:15]
    ds_read_b128 v[168:171], v98 offset:32768
    ds_read_b64_tr_b16 v[72:73], v100 offset:53248
    ds_read_b64_tr_b16 v[74:75], v100 offset:53760
    s_add_u32 m0, s3, 32768
    s_nop 0
    buffer_load_dwordx4 v102, s[24:27], s64 offen offset:0 lds
    buffer_load_dwordx4 v103, s[24:27], s64 offen offset:1024 lds
    s_add_i32 s64, s64, 128
    s_add_i32 s65, s65, 229376
    s_add_u32 s11, s11, 131072
    v_mfma_f32_32x32x16_bf16 v[16:31], v[84:87], v[160:163], v[16:31]
    ds_read_b64_tr_b16 v[76:77], v101 offset:53248
    ds_read_b64_tr_b16 v[78:79], v101 offset:53760
    v_mfma_f32_16x16x32_bf16 v[108:111], v[80:83], v[112:115], v[108:111]
    v_add_u32 v37, s11, v37
    v_and_b32 v118, 15, v106
    v_lshlrev_b32 v118, 6, v118
    v_lshl_add_u32 v38, v116, 4, v118
    s_mul_i32 s63, s6, 34816
    s_mul_i32 s8, s8, 17408
    s_waitcnt lgkmcnt(5)
    v_mfma_f32_32x32x16_bf16 v[0:15], v[64:67], v[164:167], v[0:15]
    ds_read_b128 v[172:175], v99 offset:32768
    ds_read_b64_tr_b16 v[80:81], v88 offset:53248
    ds_read_b64_tr_b16 v[82:83], v88 offset:53760
    buffer_load_dwordx4 v[32:35], v104, s[12:15], s66 offen offset:128
    s_add_u32 s63, s63, s8
    s_lshl_b32 s8, s7, 12
    s_add_u32 s63, s63, s8
    v_mfma_f32_32x32x16_bf16 v[16:31], v[68:71], v[164:167], v[16:31]
    ds_read_b64_tr_b16 v[84:85], v89 offset:53248
    ds_read_b64_tr_b16 v[86:87], v89 offset:53760
    s_lshl_b32 s8, s58, 10
    s_add_u32 s63, s63, s8
    s_add_u32 s63, s63, 0x200000
    s_waitcnt vmcnt(7) lgkmcnt(5)
    v_xor_b32 v100, 0x10000, v100
    v_xor_b32 v101, 0x10000, v101
    v_xor_b32 v88, 0x10000, v88
    v_xor_b32 v89, 0x10000, v89
    v_xor_b32 v96, 0x10000, v96
    v_xor_b32 v97, 0x10000, v97
    v_xor_b32 v98, 0x10000, v98
    v_xor_b32 v99, 0x10000, v99
    s_barrier
    v_mfma_f32_32x32x16_bf16 v[0:15], v[72:75], v[168:171], v[0:15]
    ds_read_b128 v[176:179], v96 offset:0
    ds_read_b64_tr_b16 v[64:65], v100 offset:16384
    ds_read_b64_tr_b16 v[66:67], v100 offset:16896
    s_add_u32 m0, s69, 81920
    s_nop 0
    buffer_load_dwordx4 v104, s[28:31], s65 offen lds
    s_add_u32 m0, s69, 90112
    s_nop 0
    buffer_load_dwordx4 v104, s[32:35], s65 offen lds
    v_mfma_f32_32x32x16_bf16 v[16:31], v[76:79], v[168:171], v[16:31]
    ds_read_b64_tr_b16 v[68:69], v101 offset:16384
    ds_read_b64_tr_b16 v[70:71], v101 offset:16896
    v_mfma_f32_16x16x32_bf16 v[108:111], v[72:75], v[112:115], v[108:111]
    s_waitcnt lgkmcnt(5)
    v_mfma_f32_32x32x16_bf16 v[0:15], v[80:83], v[172:175], v[0:15]
    ds_read_b128 v[180:183], v97 offset:0
    ds_read_b64_tr_b16 v[72:73], v88 offset:16384
    ds_read_b64_tr_b16 v[74:75], v88 offset:16896
    v_mfma_f32_32x32x16_bf16 v[16:31], v[84:87], v[172:175], v[16:31]
    ds_read_b64_tr_b16 v[76:77], v89 offset:16384
    ds_read_b64_tr_b16 v[78:79], v89 offset:16896
    s_waitcnt lgkmcnt(5)
    v_mfma_f32_32x32x16_bf16 v[0:15], v[64:67], v[176:179], v[0:15]
    ds_read_b128 v[184:187], v98 offset:0
    ds_read_b64_tr_b16 v[80:81], v100 offset:20480
    ds_read_b64_tr_b16 v[82:83], v100 offset:20992
    s_add_u32 m0, s3, 65536
    s_nop 0
    buffer_load_dwordx4 v102, s[24:27], s64 offen offset:0 lds
    buffer_load_dwordx4 v103, s[24:27], s64 offen offset:1024 lds
    s_add_i32 s64, s64, 128
    s_add_i32 s65, s65, 229376
    v_mfma_f32_32x32x16_bf16 v[16:31], v[68:71], v[176:179], v[16:31]
    ds_read_b64_tr_b16 v[84:85], v101 offset:20480
    ds_read_b64_tr_b16 v[86:87], v101 offset:20992
    v_mfma_f32_16x16x32_bf16 v[108:111], v[64:67], v[112:115], v[108:111]
    s_waitcnt lgkmcnt(5)
    v_mfma_f32_32x32x16_bf16 v[0:15], v[72:75], v[180:183], v[0:15]
    ds_read_b128 v[188:191], v99 offset:0
    ds_read_b64_tr_b16 v[64:65], v88 offset:20480
    ds_read_b64_tr_b16 v[66:67], v88 offset:20992
    v_mfma_f32_32x32x16_bf16 v[16:31], v[76:79], v[180:183], v[16:31]
    ds_read_b64_tr_b16 v[68:69], v89 offset:20480
    ds_read_b64_tr_b16 v[70:71], v89 offset:20992
    s_waitcnt vmcnt(5) lgkmcnt(5)
    s_barrier
    v_mfma_f32_32x32x16_bf16 v[0:15], v[80:83], v[184:187], v[0:15]
    ds_read_b128 v[192:195], v96 offset:32768
    ds_read_b64_tr_b16 v[72:73], v100 offset:49152
    ds_read_b64_tr_b16 v[74:75], v100 offset:49664
    s_add_u32 m0, s69, 114688
    s_nop 0
    buffer_load_dwordx4 v104, s[28:31], s65 offen lds
    s_add_u32 m0, s69, 122880
    s_nop 0
    buffer_load_dwordx4 v104, s[32:35], s65 offen lds
    v_mfma_f32_32x32x16_bf16 v[16:31], v[84:87], v[184:187], v[16:31]
    ds_read_b64_tr_b16 v[76:77], v101 offset:49152
    ds_read_b64_tr_b16 v[78:79], v101 offset:49664
    v_mfma_f32_16x16x32_bf16 v[108:111], v[80:83], v[112:115], v[108:111]
    ds_read_b64_tr_b16 v[40:41], v37
    ds_read_b64_tr_b16 v[42:43], v37 offset:512
    ds_read_b64_tr_b16 v[48:49], v45
    ds_read_b64_tr_b16 v[50:51], v45 offset:128
    s_waitcnt lgkmcnt(5)
    v_mfma_f32_32x32x16_bf16 v[0:15], v[64:67], v[188:191], v[0:15]
    ds_read_b128 v[196:199], v97 offset:32768
    ds_read_b64_tr_b16 v[80:81], v88 offset:49152
    ds_read_b64_tr_b16 v[82:83], v88 offset:49664
    v_mfma_f32_32x32x16_bf16 v[16:31], v[68:71], v[188:191], v[16:31]
    ds_read_b64_tr_b16 v[84:85], v89 offset:49152
    ds_read_b64_tr_b16 v[86:87], v89 offset:49664
    s_waitcnt lgkmcnt(5)
    v_mfma_f32_32x32x16_bf16 v[0:15], v[72:75], v[192:195], v[0:15]
    ds_read_b128 v[200:203], v98 offset:32768
    ds_read_b64_tr_b16 v[64:65], v100 offset:53248
    ds_read_b64_tr_b16 v[66:67], v100 offset:53760
    buffer_store_dwordx4 v[48:51], v38, s[36:39], s17 offen sc1
    buffer_store_dwordx4 v[40:43], v38, s[36:39], s63 offen sc1
    s_add_u32 m0, s3, 98304
    s_nop 0
    buffer_load_dwordx4 v102, s[24:27], s64 offen offset:0 lds
    buffer_load_dwordx4 v103, s[24:27], s64 offen offset:1024 lds
    s_add_i32 s64, s64, 128
    s_add_i32 s65, s65, 229376
    v_mfma_f32_32x32x16_bf16 v[16:31], v[76:79], v[192:195], v[16:31]
    ds_read_b64_tr_b16 v[68:69], v101 offset:53248
    ds_read_b64_tr_b16 v[70:71], v101 offset:53760
    v_mfma_f32_16x16x32_bf16 v[108:111], v[72:75], v[112:115], v[108:111]
    s_waitcnt lgkmcnt(5)
    v_mfma_f32_32x32x16_bf16 v[0:15], v[80:83], v[196:199], v[0:15]
    ds_read_b128 v[204:207], v99 offset:32768
    ds_read_b64_tr_b16 v[72:73], v88 offset:53248
    ds_read_b64_tr_b16 v[74:75], v88 offset:53760
    v_mfma_f32_32x32x16_bf16 v[16:31], v[84:87], v[196:199], v[16:31]
    ds_read_b64_tr_b16 v[76:77], v89 offset:53248
    ds_read_b64_tr_b16 v[78:79], v89 offset:53760
    s_waitcnt vmcnt(6) lgkmcnt(5)
    v_xor_b32 v100, 0x10000, v100
    v_xor_b32 v101, 0x10000, v101
    v_xor_b32 v88, 0x10000, v88
    v_xor_b32 v89, 0x10000, v89
    v_xor_b32 v96, 0x10000, v96
    v_xor_b32 v97, 0x10000, v97
    v_xor_b32 v98, 0x10000, v98
    v_xor_b32 v99, 0x10000, v99
    s_barrier
    v_mfma_f32_32x32x16_bf16 v[0:15], v[64:67], v[200:203], v[0:15]
    ds_read_b128 v[208:211], v96 offset:0
    ds_read_b64_tr_b16 v[80:81], v100 offset:16384
    ds_read_b64_tr_b16 v[82:83], v100 offset:16896
    s_add_u32 m0, s69, 16384
    s_nop 0
    buffer_load_dwordx4 v104, s[28:31], s65 offen lds
    s_add_u32 m0, s69, 24576
    s_nop 0
    buffer_load_dwordx4 v104, s[32:35], s65 offen lds
    v_mfma_f32_32x32x16_bf16 v[16:31], v[68:71], v[200:203], v[16:31]
    ds_read_b64_tr_b16 v[84:85], v101 offset:16384
    ds_read_b64_tr_b16 v[86:87], v101 offset:16896
    v_mfma_f32_16x16x32_bf16 v[108:111], v[64:67], v[112:115], v[108:111]
    s_waitcnt lgkmcnt(5)
    v_mfma_f32_32x32x16_bf16 v[0:15], v[72:75], v[204:207], v[0:15]
    ds_read_b128 v[212:215], v97 offset:0
    ds_read_b64_tr_b16 v[64:65], v88 offset:16384
    ds_read_b64_tr_b16 v[66:67], v88 offset:16896
    v_mfma_f32_32x32x16_bf16 v[16:31], v[76:79], v[204:207], v[16:31]
    ds_read_b64_tr_b16 v[68:69], v89 offset:16384
    ds_read_b64_tr_b16 v[70:71], v89 offset:16896
    s_waitcnt lgkmcnt(5)
    v_mfma_f32_32x32x16_bf16 v[0:15], v[80:83], v[208:211], v[0:15]
    ds_read_b128 v[216:219], v98 offset:0
    ds_read_b64_tr_b16 v[72:73], v100 offset:20480
    ds_read_b64_tr_b16 v[74:75], v100 offset:20992
    s_add_u32 m0, s3, 0
    s_nop 0
    buffer_load_dwordx4 v102, s[24:27], s64 offen offset:0 lds
    buffer_load_dwordx4 v103, s[24:27], s64 offen offset:1024 lds
    s_mul_i32 s65, s57, 57344
    s_add_u32 s65, s65, 128
    v_mfma_f32_32x32x16_bf16 v[16:31], v[84:87], v[208:211], v[16:31]
    ds_read_b64_tr_b16 v[76:77], v101 offset:20480
    ds_read_b64_tr_b16 v[78:79], v101 offset:20992
    v_mfma_f32_16x16x32_bf16 v[108:111], v[80:83], v[112:115], v[108:111]
    s_waitcnt lgkmcnt(5)
    v_mfma_f32_32x32x16_bf16 v[0:15], v[64:67], v[212:215], v[0:15]
    ds_read_b128 v[220:223], v99 offset:0
    ds_read_b64_tr_b16 v[80:81], v88 offset:20480
    ds_read_b64_tr_b16 v[82:83], v88 offset:20992
    v_mfma_f32_32x32x16_bf16 v[16:31], v[68:71], v[212:215], v[16:31]
    ds_read_b64_tr_b16 v[84:85], v89 offset:20480
    ds_read_b64_tr_b16 v[86:87], v89 offset:20992
    s_waitcnt vmcnt(4) lgkmcnt(5)
    s_barrier
    v_mfma_f32_32x32x16_bf16 v[0:15], v[72:75], v[216:219], v[0:15]
    ds_read_b128 v[224:227], v96 offset:32768
    ds_read_b64_tr_b16 v[64:65], v100 offset:49152
    ds_read_b64_tr_b16 v[66:67], v100 offset:49664
    s_add_u32 m0, s3, 32768
    s_nop 0
    buffer_load_dwordx4 v104, s[28:31], s65 offen offset:0 lds
    buffer_load_dwordx4 v105, s[28:31], s65 offen offset:1024 lds
    s_lshl_b32 s21, s59, 2
    s_add_u32 s21, s21, s58
    s_mul_i32 s20, s21, 112
    s_lshl_b32 s21, s21, 8
    v_mfma_f32_32x32x16_bf16 v[16:31], v[76:79], v[216:219], v[16:31]
    ds_read_b64_tr_b16 v[68:69], v101 offset:49152
    ds_read_b64_tr_b16 v[70:71], v101 offset:49664
    v_mfma_f32_16x16x32_bf16 v[108:111], v[72:75], v[112:115], v[108:111]
    s_add_u32 s21, s21, 0x10000
    v_and_b32 v90, 31, v106
    v_lshlrev_b32 v92, 2, v90
    v_lshlrev_b32 v90, 3, v90
    s_lshl_b32 s22, s60, 3
    s_add_u32 s20, s20, s22
    s_waitcnt lgkmcnt(5)
    v_mfma_f32_32x32x16_bf16 v[0:15], v[80:83], v[220:223], v[0:15]
    ds_read_b128 v[228:231], v97 offset:32768
    ds_read_b64_tr_b16 v[72:73], v88 offset:49152
    ds_read_b64_tr_b16 v[74:75], v88 offset:49664
    s_lshl_b32 s20, s20, 10
    s_add_u32 s20, s20, 0x600800
    s_lshl_b32 s22, s59, 4
    s_add_u32 s22, s22, s60
    s_lshl_b32 s22, s22, 7
    v_mfma_f32_32x32x16_bf16 v[16:31], v[84:87], v[220:223], v[16:31]
    ds_read_b64_tr_b16 v[76:77], v89 offset:49152
    ds_read_b64_tr_b16 v[78:79], v89 offset:49664
    s_add_u32 s22, s22, 0x60000
    v_and_b32 v91, 15, v106
    v_lshlrev_b32 v91, 6, v91
    v_lshrrev_b32 v116, 4, v106
    v_lshl_add_u32 v91, v116, 4, v91
    s_waitcnt lgkmcnt(5)
    v_mfma_f32_32x32x16_bf16 v[0:15], v[64:67], v[224:227], v[0:15]
    ds_read_b128 v[232:235], v98 offset:32768
    ds_read_b64_tr_b16 v[80:81], v100 offset:53248
    ds_read_b64_tr_b16 v[82:83], v100 offset:53760
    s_add_u32 m0, s3, 49152
    s_nop 0
    buffer_load_dwordx4 v104, s[32:35], s65 offen offset:0 lds
    buffer_load_dwordx4 v105, s[32:35], s65 offen offset:1024 lds
    s_add_u32 s65, s65, 458752
    s_and_b32 s23, s58, 1
    s_lshl_b32 s23, s23, 7
    s_add_u32 s23, s23, 153856
    v_mfma_f32_32x32x16_bf16 v[16:31], v[68:71], v[224:227], v[16:31]
    ds_read_b64_tr_b16 v[84:85], v101 offset:53248
    ds_read_b64_tr_b16 v[86:87], v101 offset:53760
    v_mfma_f32_16x16x32_bf16 v[108:111], v[64:67], v[112:115], v[108:111]
    v_add_u32 v92, s23, v92
    s_and_b32 s7, s58, 2
    s_lshl_b32 s7, s7, 8
    s_add_u32 s23, s23, s7
    v_add_u32 v91, s23, v91
    v_xor_b32 v93, 128, v92
    s_waitcnt lgkmcnt(5)
    v_mfma_f32_32x32x16_bf16 v[0:15], v[72:75], v[228:231], v[0:15]
    ds_read_b128 v[236:239], v99 offset:32768
    ds_read_b64_tr_b16 v[64:65], v88 offset:53248
    ds_read_b64_tr_b16 v[66:67], v88 offset:53760
    buffer_load_dwordx2 v[118:119], v90, s[36:39], s21 offen sc1
    v_mfma_f32_32x32x16_bf16 v[16:31], v[76:79], v[228:231], v[16:31]
    ds_read_b64_tr_b16 v[68:69], v89 offset:53248
    ds_read_b64_tr_b16 v[70:71], v89 offset:53760
    s_waitcnt vmcnt(5) lgkmcnt(5)
    v_xor_b32 v100, 0x10000, v100
    v_xor_b32 v101, 0x10000, v101
    v_xor_b32 v88, 0x10000, v88
    v_xor_b32 v89, 0x10000, v89
    v_xor_b32 v96, 0x10000, v96
    v_xor_b32 v97, 0x10000, v97
    v_xor_b32 v98, 0x10000, v98
    v_xor_b32 v99, 0x10000, v99
    s_barrier
    v_mfma_f32_32x32x16_bf16 v[0:15], v[80:83], v[232:235], v[0:15]
    ds_read_b128 v[240:243], v96 offset:0
    ds_read_b64_tr_b16 v[72:73], v100 offset:16384
    ds_read_b64_tr_b16 v[74:75], v100 offset:16896
    s_add_u32 m0, s3, 65536
    s_nop 0
    buffer_load_dwordx4 v104, s[28:31], s65 offen offset:0 lds
    buffer_load_dwordx4 v105, s[28:31], s65 offen offset:1024 lds
    v_mfma_f32_32x32x16_bf16 v[16:31], v[84:87], v[232:235], v[16:31]
    ds_read_b64_tr_b16 v[76:77], v101 offset:16384
    ds_read_b64_tr_b16 v[78:79], v101 offset:16896
    v_mfma_f32_16x16x32_bf16 v[108:111], v[80:83], v[112:115], v[108:111]
    s_waitcnt lgkmcnt(5)
    v_mfma_f32_32x32x16_bf16 v[0:15], v[64:67], v[236:239], v[0:15]
    ds_read_b128 v[244:247], v97 offset:0
    ds_read_b64_tr_b16 v[80:81], v88 offset:16384
    ds_read_b64_tr_b16 v[82:83], v88 offset:16896
    v_mfma_f32_32x32x16_bf16 v[16:31], v[68:71], v[236:239], v[16:31]
    ds_read_b64_tr_b16 v[84:85], v89 offset:16384
    ds_read_b64_tr_b16 v[86:87], v89 offset:16896
    s_waitcnt lgkmcnt(5)
    v_mfma_f32_32x32x16_bf16 v[0:15], v[72:75], v[240:243], v[0:15]
    ds_read_b128 v[248:251], v98 offset:0
    ds_read_b64_tr_b16 v[64:65], v100 offset:20480
    ds_read_b64_tr_b16 v[66:67], v100 offset:20992
    s_add_u32 m0, s3, 81920
    s_nop 0
    buffer_load_dwordx4 v104, s[32:35], s65 offen offset:0 lds
    buffer_load_dwordx4 v105, s[32:35], s65 offen offset:1024 lds
    s_add_u32 s65, s65, 458752
    v_mfma_f32_32x32x16_bf16 v[16:31], v[76:79], v[240:243], v[16:31]
    ds_read_b64_tr_b16 v[68:69], v101 offset:20480
    ds_read_b64_tr_b16 v[70:71], v101 offset:20992
    v_mfma_f32_16x16x32_bf16 v[108:111], v[72:75], v[112:115], v[108:111]
    s_waitcnt lgkmcnt(5)
    v_mfma_f32_32x32x16_bf16 v[0:15], v[80:83], v[244:247], v[0:15]
    ds_read_b128 v[252:255], v99 offset:0
    ds_read_b64_tr_b16 v[72:73], v88 offset:20480
    ds_read_b64_tr_b16 v[74:75], v88 offset:20992
    s_and_b32 s4, s58, 1
    s_lshl_b32 s4, s4, 13
    v_mfma_f32_32x32x16_bf16 v[16:31], v[84:87], v[244:247], v[16:31]
    ds_read_b64_tr_b16 v[76:77], v89 offset:20480
    ds_read_b64_tr_b16 v[78:79], v89 offset:20992
    s_xor_b32 s5, s4, 8192
    s_waitcnt vmcnt(5) lgkmcnt(0)
    v_add_u32 v100, s4, v100
    v_add_u32 v101, s5, v101
    v_add_u32 v88, s4, v88
    v_add_u32 v89, s5, v89
    s_barrier
    v_mfma_f32_32x32x16_bf16 v[0:15], v[64:67], v[248:251], v[0:15]
    ds_read_b64_tr_b16 v[80:81], v100 offset:32768
    ds_read_b64_tr_b16 v[82:83], v100 offset:33280
    ds_read_b64_tr_b16 v[84:85], v101 offset:32768
    v_mfma_f32_32x32x16_bf16 v[16:31], v[68:71], v[248:251], v[16:31]
    ds_read_b64_tr_b16 v[86:87], v101 offset:33280
    v_mfma_f32_16x16x32_bf16 v[108:111], v[64:67], v[112:115], v[108:111]
    s_waitcnt lgkmcnt(4)
    v_mfma_f32_32x32x16_bf16 v[0:15], v[72:75], v[252:255], v[0:15]
    ds_read_b64_tr_b16 v[64:65], v88 offset:32768
    ds_read_b64_tr_b16 v[66:67], v88 offset:33280
    ds_read_b64_tr_b16 v[68:69], v89 offset:32768
    v_mfma_f32_32x32x16_bf16 v[16:31], v[76:79], v[252:255], v[16:31]
    ds_read_b64_tr_b16 v[70:71], v89 offset:33280
    s_waitcnt lgkmcnt(4)
    v_mfma_f32_32x32x16_bf16 v[32:47], v[80:83], v[128:131], 0
    ds_read_b64_tr_b16 v[72:73], v100 offset:36864
    ds_read_b64_tr_b16 v[74:75], v100 offset:37376
    ds_read_b64_tr_b16 v[76:77], v101 offset:36864
    s_mov_b32 exec_lo, 0x00030003
    s_mov_b32 exec_hi, 0x00030003
    ds_write_b128 v91, v[108:111] offset:0
    s_mov_b64 exec, -1
    s_waitcnt vmcnt(4)
    v_cmp_ne_u32 vcc, s56, v119
    s_cbranch_vccz L_GR_F_OK
    s_mov_b32 s6, 0
L_GR_F_RETRY:
    s_sleep 4
    buffer_load_dwordx2 v[118:119], v90, s[36:39], s21 offen sc1
    s_add_u32 s6, s6, 1
    s_cmp_gt_u32 s6, 0x8000
    s_waitcnt vmcnt(0)
    s_cbranch_scc1 L_GR_F_OK
    v_cmp_ne_u32 vcc, s56, v119
    s_cbranch_vccnz L_GR_F_RETRY
L_GR_F_OK:
    v_mfma_f32_32x32x16_bf16 v[48:63], v[84:87], v[128:131], 0
    ds_read_b64_tr_b16 v[78:79], v101 offset:37376
    v_mfma_f32_16x16x32_bf16 v[108:111], v[80:83], v[112:115], 0
    v_and_b32 v94, 0xffff0000, v118
    v_rcp_f32 v94, v94
    v_lshlrev_b32 v95, 16, v118
    v_mul_f32 v94, v94, v94
    s_waitcnt lgkmcnt(0)
    s_barrier
    v_mfma_f32_32x32x16_bf16 v[32:47], v[64:67], v[132:135], v[32:47]
    ds_read_b64_tr_b16 v[80:81], v88 offset:36864
    ds_read_b64_tr_b16 v[82:83], v88 offset:37376
    ds_read_b64_tr_b16 v[84:85], v89 offset:36864
    s_add_u32 m0, s3, 98304
    s_nop 0
    buffer_load_dwordx4 v104, s[28:31], s65 offen offset:0 lds
    buffer_load_dwordx4 v105, s[28:31], s65 offen offset:1024 lds
    s_and_b32 s16, s61, 3
    s_lshl_b32 s16, s16, 5
    s_lshr_b32 s18, s2, 3
    s_add_u32 s16, s16, s18
    v_mfma_f32_32x32x16_bf16 v[48:63], v[68:71], v[132:135], v[48:63]
    ds_read_b64_tr_b16 v[86:87], v89 offset:37376
    s_lshr_b32 s18, s61, 2
    s_lshl_b32 s17, s18, 8
    s_add_u32 s17, s17, s16
    s_lshl_b32 s16, s16, 1
    s_add_u32 s16, s16, s18
    v_and_b32 v125, 15, v106
    v_lshrrev_b32 v126, 4, v106
    s_waitcnt lgkmcnt(4)
    v_mfma_f32_32x32x16_bf16 v[32:47], v[72:75], v[136:139], v[32:47]
    ds_read_b64_tr_b16 v[64:65], v100 offset:40960
    ds_read_b64_tr_b16 v[66:67], v100 offset:41472
    ds_read_b64_tr_b16 v[68:69], v101 offset:40960
    ds_read_b32 v131, v92 offset:0
    ds_read_b32 v130, v92 offset:512
    ds_read_b32 v135, v93 offset:0
    ds_read_b32 v134, v93 offset:512
    v_and_b32 v122, 31, v106
    v_lshlrev_b32 v122, 7, v122
    s_mov_b32 s12, 0x30000
    v_lshlrev_b32 v120, 7, v125
    v_mfma_f32_32x32x16_bf16 v[48:63], v[76:79], v[136:139], v[48:63]
    ds_read_b64_tr_b16 v[70:71], v101 offset:41472
    v_mfma_f32_16x16x32_bf16 v[108:111], v[72:75], v[112:115], v[108:111]
    v_lshl_add_u32 v120, v126, 4, v120
    s_lshr_b32 s18, s58, 1
    s_lshl_b32 s18, s18, 7
    s_add_u32 s17, s17, s18
    s_mul_i32 s17, s17, 4224
    s_and_b32 s18, s58, 1
    s_lshl_b32 s18, s18, 11
    s_waitcnt lgkmcnt(4)
    v_mfma_f32_32x32x16_bf16 v[32:47], v[80:83], v[140:143], v[32:47]
    ds_read_b64_tr_b16 v[72:73], v88 offset:40960
    ds_read_b64_tr_b16 v[74:75], v88 offset:41472
    ds_read_b64_tr_b16 v[76:77], v89 offset:40960
    s_add_u32 m0, s3, 114688
    s_nop 0
    buffer_load_dwordx4 v104, s[32:35], s65 offen offset:0 lds
    buffer_load_dwordx4 v105, s[32:35], s65 offen offset:1024 lds
    s_add_u32 s65, s65, 458752
    s_add_u32 s17, s17, s18
    s_add_u32 s17, s17, 0xe00000
    v_mul_u32_u24 v121, 34816, v125
    v_lshl_add_u32 v121, v126, 4, v121
    v_mfma_f32_32x32x16_bf16 v[48:63], v[84:87], v[140:143], v[48:63]
    ds_read_b64_tr_b16 v[78:79], v89 offset:41472
    v_and_b32 v118, 7, v106
    v_lshl_add_u32 v121, v118, 6, v121
    s_mul_i32 s19, s58, 557056
    s_add_u32 s19, s19, 0x200000
    s_lshl_b32 s18, s16, 6
    s_add_u32 s18, s18, s19
    s_add_u32 s68, s18, 17408
    s_waitcnt lgkmcnt(4)
    v_mfma_f32_32x32x16_bf16 v[32:47], v[64:67], v[144:147], v[32:47]
    ds_read_b64_tr_b16 v[80:81], v100 offset:45056
    ds_read_b64_tr_b16 v[82:83], v100 offset:45568
    ds_read_b64_tr_b16 v[84:85], v101 offset:45056
    v_add_f32 v131, v131, v130
    v_cvt_pk_bf16_f32 v128, v131, v131
    v_lshlrev_b32 v130, 16, v128
    v_sub_f32 v131, v131, v130
    v_cvt_pk_bf16_f32 v128, v130, v131
    v_and_b32 v130, 0xffff0000, v128
    v_sub_f32 v131, v131, v130
    v_cvt_pk_bf16_f32 v129, v131, 0
    v_mov_b32 v130, 0
    v_mov_b32 v131, 0
    v_add_f32 v135, v135, v134
    v_cvt_pk_bf16_f32 v132, v135, v135
    v_lshlrev_b32 v134, 16, v132
    v_mfma_f32_32x32x16_bf16 v[48:63], v[68:71], v[144:147], v[48:63]
    ds_read_b64_tr_b16 v[86:87], v101 offset:45568
    v_mfma_f32_16x16x32_bf16 v[108:111], v[64:67], v[112:115], v[108:111]
    v_sub_f32 v135, v135, v134
    v_cvt_pk_bf16_f32 v132, v134, v135
    v_and_b32 v134, 0xffff0000, v132
    v_sub_f32 v135, v135, v134
    v_cvt_pk_bf16_f32 v133, v135, 0
    v_mov_b32 v134, 0
    v_mov_b32 v135, 0
    v_cmp_gt_u32 vcc, 32, v106
    v_cvt_pk_bf16_f32 v137, -v95, -v95
    s_nop 0
    v_cndmask_b32 v136, 0, v137, vcc
    v_mov_b32 v137, v136
    v_mov_b32 v138, 0
    v_mov_b32 v139, 0
    s_waitcnt lgkmcnt(4)
    v_mfma_f32_32x32x16_bf16 v[32:47], v[72:75], v[148:151], v[32:47]
    ds_read_b64_tr_b16 v[64:65], v88 offset:45056
    ds_read_b64_tr_b16 v[66:67], v88 offset:45568
    ds_read_b64_tr_b16 v[68:69], v89 offset:45056
    v_mfma_f32_32x32x16_bf16 v[0:15], v[128:131], v[136:139], v[0:15]
    v_mfma_f32_32x32x16_bf16 v[48:63], v[76:79], v[148:151], v[48:63]
    ds_read_b64_tr_b16 v[70:71], v89 offset:45568
    v_mfma_f32_32x32x16_bf16 v[16:31], v[132:135], v[136:139], v[16:31]
    s_waitcnt vmcnt(4) lgkmcnt(0)
    v_xor_b32 v100, 0x10000, v100
    v_xor_b32 v101, 0x10000, v101
    v_xor_b32 v88, 0x10000, v88
    v_xor_b32 v89, 0x10000, v89
    s_barrier
    v_mfma_f32_32x32x16_bf16 v[32:47], v[80:83], v[152:155], v[32:47]
    ds_read_b64_tr_b16 v[72:73], v100 offset:0
    ds_read_b64_tr_b16 v[74:75], v100 offset:512
    ds_read_b64_tr_b16 v[76:77], v101 offset:0
    v_mul_f32 v0, v0, v94
    v_mul_f32 v1, v1, v94
    v_mul_f32 v2, v2, v94
    v_mul_f32 v3, v3, v94
    v_mul_f32 v4, v4, v94
    v_mul_f32 v5, v5, v94
    v_mul_f32 v6, v6, v94
    v_mul_f32 v7, v7, v94
    v_mul_f32 v0, v0, v16
    v_mul_f32 v1, v1, v17
    v_mul_f32 v2, v2, v18
    v_mfma_f32_32x32x16_bf16 v[48:63], v[84:87], v[152:155], v[48:63]
    ds_read_b64_tr_b16 v[78:79], v101 offset:512
    v_mfma_f32_16x16x32_bf16 v[108:111], v[80:83], v[112:115], v[108:111]
    v_mul_f32 v3, v3, v19
    v_mul_f32 v4, v4, v20
    v_mul_f32 v5, v5, v21
    v_mul_f32 v6, v6, v22
    v_mul_f32 v7, v7, v23
    v_cvt_pk_bf16_f32 v16, v0, v1
    v_cvt_pk_bf16_f32 v17, v2, v3
    v_cvt_pk_bf16_f32 v18, v4, v5
    v_cvt_pk_bf16_f32 v19, v6, v7
    buffer_store_dwordx4 v[16:19], v107, s[36:39], s20 offen offset:0 sc1
    s_waitcnt lgkmcnt(4)
    v_mfma_f32_32x32x16_bf16 v[32:47], v[64:67], v[156:159], v[32:47]
    ds_read_b64_tr_b16 v[80:81], v88 offset:0
    ds_read_b64_tr_b16 v[82:83], v88 offset:512
    ds_read_b64_tr_b16 v[84:85], v89 offset:0
    v_mul_f32 v8, v8, v94
    v_mul_f32 v9, v9, v94
    v_mul_f32 v10, v10, v94
    v_mul_f32 v11, v11, v94
    v_mul_f32 v12, v12, v94
    v_mul_f32 v13, v13, v94
    v_mul_f32 v14, v14, v94
    v_mul_f32 v15, v15, v94
    v_mul_f32 v8, v8, v24
    v_mul_f32 v9, v9, v25
    v_mul_f32 v10, v10, v26
    v_mfma_f32_32x32x16_bf16 v[48:63], v[68:71], v[156:159], v[48:63]
    ds_read_b64_tr_b16 v[86:87], v89 offset:512
    v_mul_f32 v11, v11, v27
    v_mul_f32 v12, v12, v28
    v_mul_f32 v13, v13, v29
    v_mul_f32 v14, v14, v30
    v_mul_f32 v15, v15, v31
    v_cvt_pk_bf16_f32 v24, v8, v9
    v_cvt_pk_bf16_f32 v25, v10, v11
    v_cvt_pk_bf16_f32 v26, v12, v13
    v_cvt_pk_bf16_f32 v27, v14, v15
    buffer_store_dwordx4 v[24:27], v107, s[36:39], s20 offen offset:1024 sc1
    s_waitcnt lgkmcnt(4)
    v_mfma_f32_32x32x16_bf16 v[32:47], v[72:75], v[160:163], v[32:47]
    ds_read_b64_tr_b16 v[64:65], v100 offset:4096
    ds_read_b64_tr_b16 v[66:67], v100 offset:4608
    ds_read_b64_tr_b16 v[68:69], v101 offset:4096
    s_add_u32 m0, s3, 0
    s_nop 0
    buffer_load_dwordx4 v104, s[28:31], s65 offen offset:0 lds
    buffer_load_dwordx4 v105, s[28:31], s65 offen offset:1024 lds
    v_mfma_f32_32x32x16_bf16 v[48:63], v[76:79], v[160:163], v[48:63]
    ds_read_b64_tr_b16 v[70:71], v101 offset:4608
    v_mfma_f32_16x16x32_bf16 v[108:111], v[72:75], v[112:115], v[108:111]
    s_waitcnt lgkmcnt(4)
    v_mfma_f32_32x32x16_bf16 v[32:47], v[80:83], v[164:167], v[32:47]
    ds_read_b64_tr_b16 v[72:73], v88 offset:4096
    ds_read_b64_tr_b16 v[74:75], v88 offset:4608
    ds_read_b64_tr_b16 v[76:77], v89 offset:4096
    v_mfma_f32_32x32x16_bf16 v[48:63], v[84:87], v[164:167], v[48:63]
    ds_read_b64_tr_b16 v[78:79], v89 offset:4608
    s_waitcnt lgkmcnt(4)
    v_mfma_f32_32x32x16_bf16 v[32:47], v[64:67], v[168:171], v[32:47]
    ds_read_b64_tr_b16 v[80:81], v100 offset:8192
    ds_read_b64_tr_b16 v[82:83], v100 offset:8704
    ds_read_b64_tr_b16 v[84:85], v101 offset:8192
    s_add_u32 m0, s3, 16384
    s_nop 0
    buffer_load_dwordx4 v104, s[32:35], s65 offen offset:0 lds
    buffer_load_dwordx4 v105, s[32:35], s65 offen offset:1024 lds
    s_add_u32 s65, s65, 458752
    v_mfma_f32_32x32x16_bf16 v[48:63], v[68:71], v[168:171], v[48:63]
    ds_read_b64_tr_b16 v[86:87], v101 offset:8704
    v_mfma_f32_16x16x32_bf16 v[108:111], v[64:67], v[112:115], v[108:111]
    s_waitcnt lgkmcnt(4)
    v_mfma_f32_32x32x16_bf16 v[32:47], v[72:75], v[172:175], v[32:47]
    ds_read_b64_tr_b16 v[64:65], v88 offset:8192
    ds_read_b64_tr_b16 v[66:67], v88 offset:8704
    ds_read_b64_tr_b16 v[68:69], v89 offset:8192
    v_and_b32 v0, 15, v106
    v_lshrrev_b32 v1, 4, v106
    s_lshl_b32 s15, s58, 4
    v_add_u32 v2, s15, v0
    v_cvt_f32_u32 v2, v2
    v_mul_f32 v3, 0x3c800000, v2
    v_lshrrev_b32 v4, 1, v1
    v_mfma_f32_32x32x16_bf16 v[48:63], v[76:79], v[172:175], v[48:63]
    ds_read_b64_tr_b16 v[70:71], v89 offset:8704
    v_lshlrev_b32 v4, 4, v4
    v_and_b32 v5, 1, v1
    v_lshl_add_u32 v4, v5, 2, v4
    v_cvt_f32_u32 v4, v4
    v_mul_f32 v4, v4, v3
    v_mov_b32 v16, v4
    v_fmamk_f32 v17, v3, 0x3f800000, v4
    s_waitcnt lgkmcnt(4)
    v_mfma_f32_32x32x16_bf16 v[32:47], v[80:83], v[176:179], v[32:47]
    ds_read_b64_tr_b16 v[72:73], v100 offset:12288
    ds_read_b64_tr_b16 v[74:75], v100 offset:12800
    ds_read_b64_tr_b16 v[76:77], v101 offset:12288
    s_lshl_b32 s5, s59, 1
    s_lshr_b32 s4, s58, 1
    s_add_u32 s5, s5, s4
    s_lshl_b32 s5, s5, 13
    s_lshl_b32 s4, s60, 8
    s_add_u32 s5, s5, s4
    s_and_b32 s4, s58, 1
    s_lshl_b32 s4, s4, 7
    s_add_u32 s5, s5, s4
    s_add_u32 s5, s5, 0x81000
    v_fmamk_f32 v18, v3, 0x40000000, v4
    v_fmamk_f32 v19, v3, 0x40400000, v4
    v_mfma_f32_32x32x16_bf16 v[48:63], v[84:87], v[176:179], v[48:63]
    ds_read_b64_tr_b16 v[78:79], v101 offset:12800
    v_mfma_f32_16x16x32_bf16 v[108:111], v[80:83], v[112:115], v[108:111]
    v_fmamk_f32 v20, v3, 0x41000000, v4
    v_fmamk_f32 v21, v3, 0x41100000, v4
    v_fmamk_f32 v22, v3, 0x41200000, v4
    v_fmamk_f32 v23, v3, 0x41300000, v4
    v_cos_f32 v8, v16
    v_sin_f32 v16, v16
    v_cos_f32 v9, v17
    v_sin_f32 v17, v17
    v_cos_f32 v10, v18
    v_sin_f32 v18, v18
    v_cos_f32 v11, v19
    v_sin_f32 v19, v19
    s_waitcnt lgkmcnt(4)
    v_mfma_f32_32x32x16_bf16 v[32:47], v[64:67], v[180:183], v[32:47]
    ds_read_b64_tr_b16 v[80:81], v88 offset:12288
    ds_read_b64_tr_b16 v[82:83], v88 offset:12800
    ds_read_b64_tr_b16 v[84:85], v89 offset:12288
    v_cos_f32 v12, v20
    v_sin_f32 v20, v20
    v_cos_f32 v13, v21
    v_sin_f32 v21, v21
    v_cos_f32 v14, v22
    v_sin_f32 v22, v22
    v_cos_f32 v15, v23
    v_mfma_f32_32x32x16_bf16 v[48:63], v[68:71], v[180:183], v[48:63]
    ds_read_b64_tr_b16 v[86:87], v89 offset:12800
    v_sin_f32 v23, v23
    v_cvt_pk_bf16_f32 v144, v8, v9
    v_cvt_pk_bf16_f32 v148, v16, v17
    v_cvt_pk_bf16_f32 v145, v10, v11
    v_cvt_pk_bf16_f32 v149, v18, v19
    v_cvt_pk_bf16_f32 v146, v12, v13
    v_cvt_pk_bf16_f32 v150, v20, v21
    s_waitcnt vmcnt(4) lgkmcnt(0)
    s_barrier
    v_mfma_f32_32x32x16_bf16 v[32:47], v[72:75], v[184:187], v[32:47]
    ds_read_b64_tr_b16 v[64:65], v100 offset:32768
    ds_read_b64_tr_b16 v[66:67], v100 offset:33280
    ds_read_b64_tr_b16 v[68:69], v101 offset:32768
    s_cmp_lg_u32 s58, 0
    s_cselect_b32 s22, 0x7000000, s22
    v_mov_b32 v116, 0
    v_mov_b32 v117, s56
    s_mov_b64 exec, 1
    buffer_store_dword v117, v116, s[36:39], s22 offen sc1
    s_mov_b64 exec, -1
    v_cvt_pk_bf16_f32 v147, v14, v15
    v_cvt_pk_bf16_f32 v151, v22, v23
    v_xor_b32 v152, 0x80008000, v148
    v_xor_b32 v153, 0x80008000, v149
    v_mfma_f32_32x32x16_bf16 v[48:63], v[76:79], v[184:187], v[48:63]
    ds_read_b64_tr_b16 v[70:71], v101 offset:33280
    v_mfma_f32_16x16x32_bf16 v[108:111], v[72:75], v[112:115], v[108:111]
    v_xor_b32 v154, 0x80008000, v150
    v_xor_b32 v155, 0x80008000, v151
    v_fmamk_f32 v16, v3, 0x42000000, v4
    v_fmamk_f32 v17, v3, 0x42040000, v4
    v_fmamk_f32 v18, v3, 0x42080000, v4
    v_fmamk_f32 v19, v3, 0x420c0000, v4
    v_fmamk_f32 v20, v3, 0x42200000, v4
    v_fmamk_f32 v21, v3, 0x42240000, v4
    v_fmamk_f32 v22, v3, 0x42280000, v4
    v_fmamk_f32 v23, v3, 0x422c0000, v4
    s_waitcnt lgkmcnt(4)
    v_mfma_f32_32x32x16_bf16 v[32:47], v[80:83], v[188:191], v[32:47]
    ds_read_b64_tr_b16 v[72:73], v88 offset:32768
    ds_read_b64_tr_b16 v[74:75], v88 offset:33280
    ds_read_b64_tr_b16 v[76:77], v89 offset:32768
    v_cos_f32 v8, v16
    v_sin_f32 v16, v16
    v_cos_f32 v9, v17
    v_sin_f32 v17, v17
    v_cos_f32 v10, v18
    v_sin_f32 v18, v18
    v_cos_f32 v11, v19
    v_mfma_f32_32x32x16_bf16 v[48:63], v[84:87], v[188:191], v[48:63]
    ds_read_b64_tr_b16 v[78:79], v89 offset:33280
    v_sin_f32 v19, v19
    v_cos_f32 v12, v20
    v_sin_f32 v20, v20
    v_cos_f32 v13, v21
    v_sin_f32 v21, v21
    v_cos_f32 v14, v22
    v_sin_f32 v22, v22
    s_waitcnt lgkmcnt(4)
    v_mfma_f32_32x32x16_bf16 v[32:47], v[64:67], v[192:195], v[32:47]
    ds_read_b64_tr_b16 v[80:81], v100 offset:36864
    ds_read_b64_tr_b16 v[82:83], v100 offset:37376
    ds_read_b64_tr_b16 v[84:85], v101 offset:36864
    v_cos_f32 v15, v23
    v_sin_f32 v23, v23
    v_cvt_pk_bf16_f32 v156, v8, v9
    v_cvt_pk_bf16_f32 v160, v16, v17
    v_cvt_pk_bf16_f32 v157, v10, v11
    v_cvt_pk_bf16_f32 v161, v18, v19
    v_cvt_pk_bf16_f32 v158, v12, v13
    v_mfma_f32_32x32x16_bf16 v[48:63], v[68:71], v[192:195], v[48:63]
    ds_read_b64_tr_b16 v[86:87], v101 offset:37376
    v_mfma_f32_16x16x32_bf16 v[108:111], v[64:67], v[112:115], v[108:111]
    v_cvt_pk_bf16_f32 v162, v20, v21
    v_cvt_pk_bf16_f32 v159, v14, v15
    v_cvt_pk_bf16_f32 v163, v22, v23
    v_xor_b32 v164, 0x80008000, v160
    v_xor_b32 v165, 0x80008000, v161
    v_xor_b32 v166, 0x80008000, v162
    v_xor_b32 v167, 0x80008000, v163
    s_waitcnt lgkmcnt(4)
    v_mfma_f32_32x32x16_bf16 v[32:47], v[72:75], v[196:199], v[32:47]
    ds_read_b64_tr_b16 v[64:65], v88 offset:36864
    ds_read_b64_tr_b16 v[66:67], v88 offset:37376
    ds_read_b64_tr_b16 v[68:69], v89 offset:36864
    v_lshlrev_b32 v1, 2, v1
    v_cvt_f32_u32 v1, v1
    v_cvt_f32_u32 v0, v0
    v_mov_b32 v5, v0
    v_mul_f32 v3, 0x3d000000, v5
    v_mul_f32 v4, v1, v3
    v_mov_b32 v16, v4
    v_mfma_f32_32x32x16_bf16 v[48:63], v[76:79], v[196:199], v[48:63]
    ds_read_b64_tr_b16 v[70:71], v89 offset:37376
    v_fmamk_f32 v17, v3, 0x3f800000, v4
    v_fmamk_f32 v18, v3, 0x40000000, v4
    v_fmamk_f32 v19, v3, 0x40400000, v4
    v_fmamk_f32 v20, v3, 0x41800000, v4
    v_fmamk_f32 v21, v3, 0x41880000, v4
    v_fmamk_f32 v22, v3, 0x41900000, v4
    v_fmamk_f32 v23, v3, 0x41980000, v4
    s_waitcnt lgkmcnt(4)
    v_mfma_f32_32x32x16_bf16 v[32:47], v[80:83], v[200:203], v[32:47]
    ds_read_b64_tr_b16 v[72:73], v100 offset:40960
    ds_read_b64_tr_b16 v[74:75], v100 offset:41472
    ds_read_b64_tr_b16 v[76:77], v101 offset:40960
    v_cos_f32 v8, v16
    v_sin_f32 v16, v16
    v_cos_f32 v9, v17
    v_sin_f32 v17, v17
    v_cos_f32 v10, v18
    v_sin_f32 v18, v18
    v_cos_f32 v11, v19
    v_mfma_f32_32x32x16_bf16 v[48:63], v[84:87], v[200:203], v[48:63]
    ds_read_b64_tr_b16 v[78:79], v101 offset:41472
    v_mfma_f32_16x16x32_bf16 v[108:111], v[80:83], v[112:115], v[108:111]
    v_sin_f32 v19, v19
    v_cos_f32 v12, v20
    v_sin_f32 v20, v20
    v_cos_f32 v13, v21
    v_sin_f32 v21, v21
    v_cos_f32 v14, v22
    s_waitcnt lgkmcnt(4)
    v_mfma_f32_32x32x16_bf16 v[32:47], v[64:67], v[204:207], v[32:47]
    ds_read_b64_tr_b16 v[80:81], v88 offset:40960
    ds_read_b64_tr_b16 v[82:83], v88 offset:41472
    ds_read_b64_tr_b16 v[84:85], v89 offset:40960
    v_sin_f32 v22, v22
    v_cos_f32 v15, v23
    v_sin_f32 v23, v23
    v_cvt_pk_bf16_f32 v168, v8, v9
    v_cvt_pk_bf16_f32 v172, v16, v17
    v_cvt_pk_bf16_f32 v169, v10, v11
    v_cvt_pk_bf16_f32 v173, v18, v19
    v_mfma_f32_32x32x16_bf16 v[48:63], v[68:71], v[204:207], v[48:63]
    ds_read_b64_tr_b16 v[86:87], v89 offset:41472
    v_cvt_pk_bf16_f32 v170, v12, v13
    v_cvt_pk_bf16_f32 v174, v20, v21
    v_cvt_pk_bf16_f32 v171, v14, v15
    v_cvt_pk_bf16_f32 v175, v22, v23
    v_xor_b32 v176, 0x80008000, v172
    v_xor_b32 v177, 0x80008000, v173
    v_xor_b32 v178, 0x80008000, v174
    s_waitcnt lgkmcnt(4)
    v_mfma_f32_32x32x16_bf16 v[32:47], v[72:75], v[208:211], v[32:47]
    ds_read_b64_tr_b16 v[64:65], v100 offset:45056
    ds_read_b64_tr_b16 v[66:67], v100 offset:45568
    ds_read_b64_tr_b16 v[68:69], v101 offset:45056
    v_xor_b32 v179, 0x80008000, v175
    v_add_f32 v5, 0x41800000, v0
    v_mul_f32 v3, 0x3d000000, v5
    v_mul_f32 v4, v1, v3
    v_mov_b32 v16, v4
    v_fmamk_f32 v17, v3, 0x3f800000, v4
    v_fmamk_f32 v18, v3, 0x40000000, v4
    v_mfma_f32_32x32x16_bf16 v[48:63], v[76:79], v[208:211], v[48:63]
    ds_read_b64_tr_b16 v[70:71], v101 offset:45568
    v_mfma_f32_16x16x32_bf16 v[108:111], v[72:75], v[112:115], v[108:111]
    v_fmamk_f32 v19, v3, 0x40400000, v4
    v_fmamk_f32 v20, v3, 0x41800000, v4
    v_fmamk_f32 v21, v3, 0x41880000, v4
    v_fmamk_f32 v22, v3, 0x41900000, v4
    v_fmamk_f32 v23, v3, 0x41980000, v4
    v_cos_f32 v8, v16
    buffer_load_dword v123, v122, s[36:39], s12 offen sc1
    s_waitcnt lgkmcnt(4)
    v_mfma_f32_32x32x16_bf16 v[32:47], v[80:83], v[212:215], v[32:47]
    ds_read_b64_tr_b16 v[72:73], v88 offset:45056
    ds_read_b64_tr_b16 v[74:75], v88 offset:45568
    ds_read_b64_tr_b16 v[76:77], v89 offset:45056
    v_sin_f32 v16, v16
    v_cos_f32 v9, v17
    v_sin_f32 v17, v17
    v_cos_f32 v10, v18
    v_sin_f32 v18, v18
    v_cos_f32 v11, v19
    v_sin_f32 v19, v19
    v_mfma_f32_32x32x16_bf16 v[48:63], v[84:87], v[212:215], v[48:63]
    ds_read_b64_tr_b16 v[78:79], v89 offset:45568
    v_cos_f32 v12, v20
    v_sin_f32 v20, v20
    v_cos_f32 v13, v21
    v_sin_f32 v21, v21
    v_cos_f32 v14, v22
    v_sin_f32 v22, v22
    v_cos_f32 v15, v23
    s_waitcnt vmcnt(2) lgkmcnt(0)
    v_xor_b32 v100, 0x10000, v100
    v_xor_b32 v101, 0x10000, v101
    v_xor_b32 v88, 0x10000, v88
    v_xor_b32 v89, 0x10000, v89
    s_barrier
    v_mfma_f32_32x32x16_bf16 v[32:47], v[64:67], v[216:219], v[32:47]
    ds_read_b64_tr_b16 v[80:81], v100 offset:0
    ds_read_b64_tr_b16 v[82:83], v100 offset:512
    ds_read_b64_tr_b16 v[84:85], v101 offset:0
    v_sin_f32 v23, v23
    v_cvt_pk_bf16_f32 v180, v8, v9
    v_cvt_pk_bf16_f32 v184, v16, v17
    v_cvt_pk_bf16_f32 v181, v10, v11
    v_cvt_pk_bf16_f32 v185, v18, v19
    v_cvt_pk_bf16_f32 v182, v12, v13
    v_cvt_pk_bf16_f32 v186, v20, v21
    v_mfma_f32_32x32x16_bf16 v[48:63], v[68:71], v[216:219], v[48:63]
    ds_read_b64_tr_b16 v[86:87], v101 offset:512
    v_mfma_f32_16x16x32_bf16 v[108:111], v[64:67], v[112:115], v[108:111]
    v_cvt_pk_bf16_f32 v183, v14, v15
    v_cvt_pk_bf16_f32 v187, v22, v23
    v_xor_b32 v188, 0x80008000, v184
    v_xor_b32 v189, 0x80008000, v185
    v_xor_b32 v190, 0x80008000, v186
    v_xor_b32 v191, 0x80008000, v187
    s_waitcnt lgkmcnt(4)
    v_mfma_f32_32x32x16_bf16 v[32:47], v[72:75], v[220:223], v[32:47]
    ds_read_b64_tr_b16 v[64:65], v88 offset:0
    ds_read_b64_tr_b16 v[66:67], v88 offset:512
    ds_read_b64_tr_b16 v[68:69], v89 offset:0
    v_mul_f32 v3, 0x3a000000, v2
    v_mul_f32 v4, v1, v3
    v_mov_b32 v16, v4
    v_fmamk_f32 v17, v3, 0x3f800000, v4
    v_fmamk_f32 v18, v3, 0x40000000, v4
    v_mfma_f32_32x32x16_bf16 v[48:63], v[76:79], v[220:223], v[48:63]
    ds_read_b64_tr_b16 v[70:71], v89 offset:512
    v_fmamk_f32 v19, v3, 0x40400000, v4
    v_fmamk_f32 v20, v3, 0x41800000, v4
    v_fmamk_f32 v21, v3, 0x41880000, v4
    v_fmamk_f32 v22, v3, 0x41900000, v4
    s_waitcnt lgkmcnt(4)
    v_mfma_f32_32x32x16_bf16 v[32:47], v[80:83], v[224:227], v[32:47]
    ds_read_b64_tr_b16 v[72:73], v100 offset:4096
    ds_read_b64_tr_b16 v[74:75], v100 offset:4608
    ds_read_b64_tr_b16 v[76:77], v101 offset:4096
    v_fmamk_f32 v23, v3, 0x41980000, v4
    v_cos_f32 v192, v16
    v_sin_f32 v200, v16
    v_cos_f32 v193, v17
    v_sin_f32 v201, v17
    v_cos_f32 v194, v18
    v_sin_f32 v202, v18
    v_cos_f32 v195, v19
    v_mfma_f32_32x32x16_bf16 v[48:63], v[84:87], v[224:227], v[48:63]
    ds_read_b64_tr_b16 v[78:79], v101 offset:4608
    v_mfma_f32_16x16x32_bf16 v[108:111], v[80:83], v[112:115], v[108:111]
    v_sin_f32 v203, v19
    s_waitcnt vmcnt(0)
    v_cmp_ne_u32 vcc, s56, v123
    s_nop 0
    s_cmp_eq_u32 vcc_lo, 0
    s_cselect_b32 s67, 1, 0
    buffer_load_dwordx4 v[128:131], v120, s[36:39], s17 offen sc1
    buffer_load_dwordx4 v[132:135], v120, s[36:39], s17 offen offset:64 sc1
    s_waitcnt lgkmcnt(4)
    v_mfma_f32_32x32x16_bf16 v[32:47], v[64:67], v[228:231], v[32:47]
    ds_read_b64_tr_b16 v[80:81], v88 offset:4096
    ds_read_b64_tr_b16 v[82:83], v88 offset:4608
    ds_read_b64_tr_b16 v[84:85], v89 offset:4096
    v_cos_f32 v196, v20
    v_sin_f32 v204, v20
    v_cos_f32 v197, v21
    v_sin_f32 v205, v21
    v_cos_f32 v198, v22
    v_mfma_f32_32x32x16_bf16 v[48:63], v[68:71], v[228:231], v[48:63]
    ds_read_b64_tr_b16 v[86:87], v89 offset:4608
    v_sin_f32 v206, v22
    v_cos_f32 v199, v23
    v_sin_f32 v207, v23
    buffer_load_dwordx4 v[136:139], v121, s[36:39], s18 offen sc1
    buffer_load_dwordx4 v[140:143], v121, s[36:39], s68 offen sc1
    s_waitcnt lgkmcnt(4)
    v_mfma_f32_32x32x16_bf16 v[32:47], v[72:75], v[232:235], v[32:47]
    ds_read_b64_tr_b16 v[64:65], v100 offset:8192
    ds_read_b64_tr_b16 v[66:67], v100 offset:8704
    ds_read_b64_tr_b16 v[68:69], v101 offset:8192
    v_cvt_f32_u32 v2, s15
    v_add_f32 v2, v2, v1
    v_mov_b32 v5, v0
    v_mul_f32 v3, 0x3a000000, v5
    v_mfma_f32_32x32x16_bf16 v[48:63], v[76:79], v[232:235], v[48:63]
    ds_read_b64_tr_b16 v[70:71], v101 offset:8704
    v_mfma_f32_16x16x32_bf16 v[108:111], v[72:75], v[112:115], v[108:111]
    v_mul_f32 v4, v2, v3
    v_mov_b32 v16, v4
    v_fmamk_f32 v17, v3, 0x3f800000, v4
    v_fmamk_f32 v18, v3, 0x40000000, v4
    s_waitcnt lgkmcnt(4)
    v_mfma_f32_32x32x16_bf16 v[32:47], v[80:83], v[236:239], v[32:47]
    ds_read_b64_tr_b16 v[72:73], v88 offset:8192
    ds_read_b64_tr_b16 v[74:75], v88 offset:8704
    ds_read_b64_tr_b16 v[76:77], v89 offset:8192
    v_fmamk_f32 v19, v3, 0x40400000, v4
    v_cos_f32 v208, v16
    v_sin_f32 v216, v16
    v_cos_f32 v209, v17
    v_mfma_f32_32x32x16_bf16 v[48:63], v[84:87], v[236:239], v[48:63]
    ds_read_b64_tr_b16 v[78:79], v89 offset:8704
    v_sin_f32 v217, v17
    v_cos_f32 v210, v18
    v_sin_f32 v218, v18
    v_cos_f32 v211, v19
    s_waitcnt lgkmcnt(4)
    v_mfma_f32_32x32x16_bf16 v[32:47], v[64:67], v[240:243], v[32:47]
    ds_read_b64_tr_b16 v[80:81], v100 offset:12288
    ds_read_b64_tr_b16 v[82:83], v100 offset:12800
    ds_read_b64_tr_b16 v[84:85], v101 offset:12288
    v_sin_f32 v219, v19
    v_add_f32 v5, 0x41800000, v0
    v_mul_f32 v3, 0x3a000000, v5
    v_mul_f32 v4, v2, v3
    v_mfma_f32_32x32x16_bf16 v[48:63], v[68:71], v[240:243], v[48:63]
    ds_read_b64_tr_b16 v[86:87], v101 offset:12800
    v_mfma_f32_16x16x32_bf16 v[108:111], v[64:67], v[112:115], v[108:111]
    v_mov_b32 v16, v4
    v_fmamk_f32 v17, v3, 0x3f800000, v4
    v_fmamk_f32 v18, v3, 0x40000000, v4
    v_fmamk_f32 v19, v3, 0x40400000, v4
    s_waitcnt lgkmcnt(4)
    v_mfma_f32_32x32x16_bf16 v[32:47], v[72:75], v[244:247], v[32:47]
    ds_read_b64_tr_b16 v[64:65], v88 offset:12288
    ds_read_b64_tr_b16 v[66:67], v88 offset:12800
    ds_read_b64_tr_b16 v[68:69], v89 offset:12288
    v_cos_f32 v212, v16
    v_sin_f32 v220, v16
    v_cos_f32 v213, v17
    v_sin_f32 v221, v17
    v_mfma_f32_32x32x16_bf16 v[48:63], v[76:79], v[244:247], v[48:63]
    ds_read_b64_tr_b16 v[70:71], v89 offset:12800
    v_cos_f32 v214, v18
    v_sin_f32 v222, v18
    v_cos_f32 v215, v19
    v_sin_f32 v223, v19
    s_waitcnt lgkmcnt(4)
    v_mfma_f32_32x32x16_bf16 v[32:47], v[80:83], v[248:251], v[32:47]
    v_mfma_f32_32x32x16_bf16 v[48:63], v[84:87], v[248:251], v[48:63]
    v_mfma_f32_16x16x32_bf16 v[108:111], v[80:83], v[112:115], v[108:111]
    s_waitcnt lgkmcnt(0)
    v_mfma_f32_32x32x16_bf16 v[32:47], v[64:67], v[252:255], v[32:47]
    s_lshl_b32 s11, s58, 13
    s_add_u32 s11, s11, 104448
    v_add_u32 v119, s11, v107
    s_waitcnt vmcnt(2)
    v_mov_b32 v124, 1
    v_mov_b32 v127, 162816
    s_cmp_eq_u32 s67, 0
    s_cbranch_scc1 L_F_NOXS
    ds_write_b128 v119, v[128:131]
    ds_write_b128 v119, v[132:135] offset:1024
    s_mov_b64 exec, 1
    ds_add_u32 v127, v124 offset:28
    s_mov_b64 exec, -1
L_F_NOXS:
    v_mfma_f32_32x32x16_bf16 v[48:63], v[68:71], v[252:255], v[48:63]
    s_mov_b32 exec_lo, 0x00030003
    s_mov_b32 exec_hi, 0x00030003
    ds_write_b128 v91, v[108:111] offset:1024
    s_mov_b64 exec, -1
    s_mov_b64 exec, 1
    ds_add_u32 v127, v124 offset:16
    s_mov_b64 exec, -1
    s_waitcnt vmcnt(0)
    v_lshlrev_b32 v0, 16, v136
    v_and_b32 v1, 0xffff0000, v136
    v_lshlrev_b32 v2, 16, v137
    v_and_b32 v3, 0xffff0000, v137
    v_lshlrev_b32 v4, 16, v138
    v_and_b32 v5, 0xffff0000, v138
    v_lshlrev_b32 v6, 16, v139
    v_and_b32 v7, 0xffff0000, v139
    v_lshlrev_b32 v8, 16, v140
    v_and_b32 v9, 0xffff0000, v140
    v_lshlrev_b32 v10, 16, v141
    v_and_b32 v11, 0xffff0000, v141
    v_lshlrev_b32 v12, 16, v142
    v_and_b32 v13, 0xffff0000, v142
    v_lshlrev_b32 v14, 16, v143
    v_and_b32 v15, 0xffff0000, v143
    v_mul_f32 v0, 0x36000000, v0
    v_mul_f32 v1, 0x36000000, v1
    v_mul_f32 v2, 0x36000000, v2
    v_mul_f32 v3, 0x36000000, v3
    v_mul_f32 v4, 0x36000000, v4
    v_mul_f32 v5, 0x36000000, v5
    v_mul_f32 v6, 0x36000000, v6
    v_mul_f32 v7, 0x36000000, v7
    v_mul_f32 v8, 0x36000000, v8
    v_mul_f32 v9, 0x36000000, v9
    v_mul_f32 v10, 0x36000000, v10
    v_mul_f32 v11, 0x36000000, v11
    v_mul_f32 v12, 0x36000000, v12
    v_mul_f32 v13, 0x36000000, v13
    v_mul_f32 v14, 0x36000000, v14
    v_mul_f32 v15, 0x36000000, v15
    s_mov_b32 s6, 0
L_LW_B1:
    ds_read_b32 v116, v127 offset:16
    s_add_u32 s6, s6, 1
    s_waitcnt lgkmcnt(0)
    v_readfirstlane_b32 s7, v116
    s_cmp_gt_u32 s6, 0x40000
    s_cbranch_scc1 L_LWD_B1
    s_cmp_ge_u32 s7, 4
    s_cbranch_scc1 L_LWD_B1
    s_branch L_LW_B1
L_LWD_B1:
    ds_read_b32 v67, v92 offset:1024
    ds_read_b32 v66, v92 offset:1536
    ds_read_b32 v71, v93 offset:1024
    ds_read_b32 v70, v93 offset:1536
    s_waitcnt lgkmcnt(0)
    v_add_f32 v67, v67, v66
    v_cvt_pk_bf16_f32 v64, v67, v67
    v_lshlrev_b32 v66, 16, v64
    v_sub_f32 v67, v67, v66
    v_cvt_pk_bf16_f32 v64, v66, v67
    v_and_b32 v66, 0xffff0000, v64
    v_sub_f32 v67, v67, v66
    v_cvt_pk_bf16_f32 v65, v67, 0
    v_mov_b32 v66, 0
    v_mov_b32 v67, 0
    v_add_f32 v71, v71, v70
    v_cvt_pk_bf16_f32 v68, v71, v71
    v_lshlrev_b32 v70, 16, v68
    v_sub_f32 v71, v71, v70
    v_cvt_pk_bf16_f32 v68, v70, v71
    v_and_b32 v70, 0xffff0000, v68
    v_sub_f32 v71, v71, v70
    v_cvt_pk_bf16_f32 v69, v71, 0
    v_mov_b32 v70, 0
    v_mov_b32 v71, 0
    v_cmp_gt_u32 vcc, 32, v106
    v_cvt_pk_bf16_f32 v73, -v95, -v95
    s_nop 0
    v_cndmask_b32 v72, 0, v73, vcc
    v_mov_b32 v73, v72
    v_mov_b32 v74, 0
    v_mov_b32 v75, 0
    s_nop 1
    v_mfma_f32_32x32x16_bf16 v[32:47], v[64:67], v[72:75], v[32:47]
    v_mfma_f32_32x32x16_bf16 v[48:63], v[68:71], v[72:75], v[48:63]
    s_nop 10
    v_mul_f32 v32, v32, v94
    v_mul_f32 v33, v33, v94
    v_mul_f32 v34, v34, v94
    v_mul_f32 v35, v35, v94
    v_mul_f32 v36, v36, v94
    v_mul_f32 v37, v37, v94
    v_mul_f32 v38, v38, v94
    v_mul_f32 v39, v39, v94
    v_mul_f32 v32, v32, v48
    v_mul_f32 v33, v33, v49
    v_mul_f32 v34, v34, v50
    v_mul_f32 v35, v35, v51
    v_mul_f32 v36, v36, v52
    v_mul_f32 v37, v37, v53
    v_mul_f32 v38, v38, v54
    v_mul_f32 v39, v39, v55
    v_cvt_pk_bf16_f32 v48, v32, v33
    v_cvt_pk_bf16_f32 v49, v34, v35
    v_cvt_pk_bf16_f32 v50, v36, v37
    v_cvt_pk_bf16_f32 v51, v38, v39
    s_add_u32 s20, s20, 4096
    buffer_store_dwordx4 v[48:51], v107, s[36:39], s20 offen offset:0 sc1
    v_mul_f32 v40, v40, v94
    v_mul_f32 v41, v41, v94
    v_mul_f32 v42, v42, v94
    v_mul_f32 v43, v43, v94
    v_mul_f32 v44, v44, v94
    v_mul_f32 v45, v45, v94
    v_mul_f32 v46, v46, v94
    v_mul_f32 v47, v47, v94
    v_mul_f32 v40, v40, v56
    v_mul_f32 v41, v41, v57
    v_mul_f32 v42, v42, v58
    v_mul_f32 v43, v43, v59
    v_mul_f32 v44, v44, v60
    v_mul_f32 v45, v45, v61
    v_mul_f32 v46, v46, v62
    v_mul_f32 v47, v47, v63
    v_cvt_pk_bf16_f32 v56, v40, v41
    v_cvt_pk_bf16_f32 v57, v42, v43
    v_cvt_pk_bf16_f32 v58, v44, v45
    v_cvt_pk_bf16_f32 v59, v46, v47
    buffer_store_dwordx4 v[56:59], v107, s[36:39], s20 offen offset:1024 sc1
    s_setprio 3
    s_branch L_P2_F
L_A:
    v_lshrrev_b32 v116, 5, v106
    v_lshlrev_b32 v116, 15, v116
    v_and_b32 v117, 31, v106
    v_lshl_add_u32 v116, v117, 4, v116
    s_lshl_b32 s64, s57, 18
    s_lshl_b32 s65, s2, 10
    s_add_u32 s64, s64, s65
    s_lshl_b32 s65, s57, 15
    s_waitcnt lgkmcnt(0)
    s_mov_b32 s24, s4
    s_mov_b32 s25, s5
    buffer_load_dwordx4 v[0:3], v116, s[24:27], s64 offen
    buffer_load_dwordx4 v[4:7], v116, s[24:27], s64 offen offset:512
    s_add_u32 s64, s64, 65536
    buffer_load_dwordx4 v[8:11], v116, s[24:27], s64 offen
    buffer_load_dwordx4 v[12:15], v116, s[24:27], s64 offen offset:512
    s_add_u32 s64, s64, 65536
    buffer_load_dwordx4 v[16:19], v116, s[24:27], s64 offen
    buffer_load_dwordx4 v[20:23], v116, s[24:27], s64 offen offset:512
    s_add_u32 s64, s64, 65536
    buffer_load_dwordx4 v[24:27], v116, s[24:27], s64 offen
    buffer_load_dwordx4 v[28:31], v116, s[24:27], s64 offen offset:512
    s_getpc_b64 s[84:85]
L_parallel_sum_pc_2:
    s_sub_u32 s84, s84, L_parallel_sum_pc_2-parallel_sum__spectral_gfnet__glu_gated_bilinear__prompt_kernel
    s_subb_u32 s85, s85, 0
    s_lshr_b32 s86, s2, 3
    s_lshl_b32 s86, s86, 3
    s_add_u32 s86, s86, s57
    s_lshl_b32 s86, s86, 6
    s_add_u32 s87, s86, 32768
    s_min_u32 s87, s87, L_END-parallel_sum__spectral_gfnet__glu_gated_bilinear__prompt_kernel-64
    s_load_dword s88, s[84:85], s86
    s_add_u32 s86, s86, 16384
    s_load_dword s89, s[84:85], s86
    s_load_dword s90, s[84:85], s87
    s_lshr_b32 s78, s62, 2
    s_xor_b32 s79, s62, 12
    s_cmp_eq_u32 s78, 3
    s_cselect_b32 s62, s79, s62
    s_cmp_eq_u32 s78, 0
    s_cselect_b32 s62, s79, s62
    s_load_dword s56, s[22:23], 0x0
    s_lshl_b32 s78, s62, 3
    s_add_u32 s78, s78, s57
    s_lshl_b32 s78, s78, 16
    s_load_dword s80, s[22:23], s78
    s_and_b32 s79, s78, 0x3f0000
    s_add_u32 s79, s79, 0x1000000
    s_load_dword s81, s[22:23], s79
    s_and_b32 s79, s78, 0x1f0000
    s_load_dword s82, s[18:19], s79
    s_min_u32 s79, s79, 0x1b0000
    s_load_dword s83, s[16:17], s79
    s_mov_b32 s36, s22
    s_mov_b32 s37, s23
    s_mov_b32 s38, 0x1400000
    s_mov_b32 s39, 0x00020000
    s_mov_b32 s44, s16
    s_mov_b32 s45, s17
    s_mov_b32 s46, 0x1c0000
    s_mov_b32 s47, 0x00020000
    s_mov_b32 s48, s18
    s_mov_b32 s49, s19
    s_mov_b32 s50, 0x200000
    s_mov_b32 s51, 0x00020000
    v_mov_b32 v116, 0
    v_lshlrev_b32 v117, 2, v106
    v_add_u32 v117, 162816, v117
    ds_write_b32 v117, v116
    s_barrier
    buffer_load_dwordx4 v[128:131], v107, s[40:43], s65 offen offset:0
    buffer_load_dwordx4 v[132:135], v107, s[40:43], s65 offen offset:1024
    buffer_load_dwordx4 v[136:139], v107, s[40:43], s65 offen offset:2048
    buffer_load_dwordx4 v[140:143], v107, s[40:43], s65 offen offset:3072
    s_add_u32 s65, s65, 4096
    buffer_load_dwordx4 v[144:147], v107, s[40:43], s65 offen offset:0
    buffer_load_dwordx4 v[148:151], v107, s[40:43], s65 offen offset:1024
    s_waitcnt vmcnt(12)
    v_lshlrev_b32 v108, 16, v0
    v_and_b32 v109, 0xffff0000, v0
    v_lshlrev_b32 v110, 16, v4
    v_and_b32 v111, 0xffff0000, v4
    v_pk_add_f32 v[32:33], v[108:109], v[110:111]
    v_pk_add_f32 v[40:41], v[108:109], v[110:111] neg_lo:[0,1] neg_hi:[0,1]
    v_lshlrev_b32 v108, 16, v1
    v_and_b32 v109, 0xffff0000, v1
    v_lshlrev_b32 v110, 16, v5
    v_and_b32 v111, 0xffff0000, v5
    v_pk_add_f32 v[34:35], v[108:109], v[110:111]
    v_pk_add_f32 v[42:43], v[108:109], v[110:111] neg_lo:[0,1] neg_hi:[0,1]
    v_lshlrev_b32 v108, 16, v2
    v_and_b32 v109, 0xffff0000, v2
    v_lshlrev_b32 v110, 16, v6
    v_and_b32 v111, 0xffff0000, v6
    v_pk_add_f32 v[36:37], v[108:109], v[110:111]
    v_pk_add_f32 v[44:45], v[108:109], v[110:111] neg_lo:[0,1] neg_hi:[0,1]
    v_lshlrev_b32 v108, 16, v3
    v_and_b32 v109, 0xffff0000, v3
    v_lshlrev_b32 v110, 16, v7
    v_and_b32 v111, 0xffff0000, v7
    v_pk_add_f32 v[38:39], v[108:109], v[110:111]
    v_pk_add_f32 v[46:47], v[108:109], v[110:111] neg_lo:[0,1] neg_hi:[0,1]
    v_pk_add_f32 v[0:1], v[32:33], v[34:35]
    v_pk_add_f32 v[2:3], v[36:37], v[38:39]
    v_pk_mul_f32 v[4:5], v[40:41], v[40:41]
    v_pk_add_f32 v[0:1], v[0:1], v[2:3]
    v_pk_fma_f32 v[4:5], v[42:43], v[42:43], v[4:5]
    v_pk_fma_f32 v[4:5], v[44:45], v[44:45], v[4:5]
    v_pk_fma_f32 v[4:5], v[46:47], v[46:47], v[4:5]
    v_add_f32 v96, v0, v1
    s_waitcnt vmcnt(10)
    v_lshlrev_b32 v108, 16, v8
    v_and_b32 v109, 0xffff0000, v8
    v_lshlrev_b32 v110, 16, v12
    v_and_b32 v111, 0xffff0000, v12
    v_pk_add_f32 v[48:49], v[108:109], v[110:111]
    v_pk_add_f32 v[56:57], v[108:109], v[110:111] neg_lo:[0,1] neg_hi:[0,1]
    v_lshlrev_b32 v108, 16, v9
    v_and_b32 v109, 0xffff0000, v9
    buffer_load_dwordx4 v[152:155], v107, s[40:43], s65 offen offset:2048
    v_lshlrev_b32 v110, 16, v13
    v_and_b32 v111, 0xffff0000, v13
    v_pk_add_f32 v[50:51], v[108:109], v[110:111]
    v_pk_add_f32 v[58:59], v[108:109], v[110:111] neg_lo:[0,1] neg_hi:[0,1]
    v_lshlrev_b32 v108, 16, v10
    v_and_b32 v109, 0xffff0000, v10
    v_lshlrev_b32 v110, 16, v14
    v_and_b32 v111, 0xffff0000, v14
    v_pk_add_f32 v[52:53], v[108:109], v[110:111]
    v_pk_add_f32 v[60:61], v[108:109], v[110:111] neg_lo:[0,1] neg_hi:[0,1]
    v_lshlrev_b32 v108, 16, v11
    v_and_b32 v109, 0xffff0000, v11
    v_lshlrev_b32 v110, 16, v15
    v_and_b32 v111, 0xffff0000, v15
    v_pk_add_f32 v[54:55], v[108:109], v[110:111]
    v_pk_add_f32 v[62:63], v[108:109], v[110:111] neg_lo:[0,1] neg_hi:[0,1]
    v_pk_add_f32 v[8:9], v[48:49], v[50:51]
    v_pk_add_f32 v[10:11], v[52:53], v[54:55]
    v_pk_mul_f32 v[12:13], v[56:57], v[56:57]
    v_pk_add_f32 v[8:9], v[8:9], v[10:11]
    v_pk_fma_f32 v[12:13], v[58:59], v[58:59], v[12:13]
    v_pk_fma_f32 v[12:13], v[60:61], v[60:61], v[12:13]
    v_pk_fma_f32 v[12:13], v[62:63], v[62:63], v[12:13]
    v_add_f32 v97, v8, v9
    s_waitcnt vmcnt(9)
    v_lshlrev_b32 v108, 16, v16
    v_and_b32 v109, 0xffff0000, v16
    v_lshlrev_b32 v110, 16, v20
    v_and_b32 v111, 0xffff0000, v20
    v_pk_add_f32 v[64:65], v[108:109], v[110:111]
    v_pk_add_f32 v[72:73], v[108:109], v[110:111] neg_lo:[0,1] neg_hi:[0,1]
    v_lshlrev_b32 v108, 16, v17
    v_and_b32 v109, 0xffff0000, v17
    v_lshlrev_b32 v110, 16, v21
    v_and_b32 v111, 0xffff0000, v21
    v_pk_add_f32 v[66:67], v[108:109], v[110:111]
    v_pk_add_f32 v[74:75], v[108:109], v[110:111] neg_lo:[0,1] neg_hi:[0,1]
    v_lshlrev_b32 v108, 16, v18
    v_and_b32 v109, 0xffff0000, v18
    v_lshlrev_b32 v110, 16, v22
    v_and_b32 v111, 0xffff0000, v22
    buffer_load_dwordx4 v[156:159], v107, s[40:43], s65 offen offset:3072
    v_pk_add_f32 v[68:69], v[108:109], v[110:111]
    v_pk_add_f32 v[76:77], v[108:109], v[110:111] neg_lo:[0,1] neg_hi:[0,1]
    v_lshlrev_b32 v108, 16, v19
    v_and_b32 v109, 0xffff0000, v19
    v_lshlrev_b32 v110, 16, v23
    v_and_b32 v111, 0xffff0000, v23
    v_pk_add_f32 v[70:71], v[108:109], v[110:111]
    v_pk_add_f32 v[78:79], v[108:109], v[110:111] neg_lo:[0,1] neg_hi:[0,1]
    v_pk_add_f32 v[16:17], v[64:65], v[66:67]
    v_pk_add_f32 v[18:19], v[68:69], v[70:71]
    v_pk_mul_f32 v[20:21], v[72:73], v[72:73]
    v_pk_add_f32 v[16:17], v[16:17], v[18:19]
    v_pk_fma_f32 v[20:21], v[74:75], v[74:75], v[20:21]
    v_pk_fma_f32 v[20:21], v[76:77], v[76:77], v[20:21]
    v_pk_fma_f32 v[20:21], v[78:79], v[78:79], v[20:21]
    v_add_f32 v98, v16, v17
    s_waitcnt vmcnt(8)
    v_lshlrev_b32 v108, 16, v24
    v_and_b32 v109, 0xffff0000, v24
    v_lshlrev_b32 v110, 16, v28
    v_and_b32 v111, 0xffff0000, v28
    v_pk_add_f32 v[80:81], v[108:109], v[110:111]
    v_pk_add_f32 v[88:89], v[108:109], v[110:111] neg_lo:[0,1] neg_hi:[0,1]
    v_lshlrev_b32 v108, 16, v25
    v_and_b32 v109, 0xffff0000, v25
    v_lshlrev_b32 v110, 16, v29
    v_and_b32 v111, 0xffff0000, v29
    v_pk_add_f32 v[82:83], v[108:109], v[110:111]
    v_pk_add_f32 v[90:91], v[108:109], v[110:111] neg_lo:[0,1] neg_hi:[0,1]
    v_lshlrev_b32 v108, 16, v26
    v_and_b32 v109, 0xffff0000, v26
    v_lshlrev_b32 v110, 16, v30
    v_and_b32 v111, 0xffff0000, v30
    v_pk_add_f32 v[84:85], v[108:109], v[110:111]
    v_pk_add_f32 v[92:93], v[108:109], v[110:111] neg_lo:[0,1] neg_hi:[0,1]
    v_lshlrev_b32 v108, 16, v27
    v_and_b32 v109, 0xffff0000, v27
    v_lshlrev_b32 v110, 16, v31
    v_and_b32 v111, 0xffff0000, v31
    v_pk_add_f32 v[86:87], v[108:109], v[110:111]
    v_pk_add_f32 v[94:95], v[108:109], v[110:111] neg_lo:[0,1] neg_hi:[0,1]
    s_add_u32 s65, s65, 4096
    buffer_load_dwordx4 v[160:163], v107, s[40:43], s65 offen offset:0
    v_pk_add_f32 v[24:25], v[80:81], v[82:83]
    v_pk_add_f32 v[26:27], v[84:85], v[86:87]
    v_pk_mul_f32 v[28:29], v[88:89], v[88:89]
    v_pk_add_f32 v[24:25], v[24:25], v[26:27]
    v_pk_fma_f32 v[28:29], v[90:91], v[90:91], v[28:29]
    v_pk_fma_f32 v[28:29], v[92:93], v[92:93], v[28:29]
    v_pk_fma_f32 v[28:29], v[94:95], v[94:95], v[28:29]
    v_add_f32 v99, v24, v25
    v_add_f32 v96, v96, v96 row_ror:8
    v_add_f32 v97, v97, v97 row_ror:8
    v_add_f32 v98, v98, v98 row_ror:8
    v_add_f32 v99, v99, v99 row_ror:8
    v_add_f32 v96, v96, v96 row_ror:4
    v_add_f32 v97, v97, v97 row_ror:4
    v_add_f32 v98, v98, v98 row_ror:4
    v_add_f32 v99, v99, v99 row_ror:4
    v_add_f32 v96, v96, v96 row_ror:2
    v_add_f32 v97, v97, v97 row_ror:2
    v_add_f32 v98, v98, v98 row_ror:2
    v_add_f32 v99, v99, v99 row_ror:2
    v_add_f32 v96, v96, v96 row_ror:1
    v_add_f32 v97, v97, v97 row_ror:1
    v_add_f32 v98, v98, v98 row_ror:1
    v_add_f32 v99, v99, v99 row_ror:1
    v_mov_b32 v108, v96
    v_mov_b32 v109, v97
    v_mov_b32 v110, v98
    v_mov_b32 v111, v99
    v_permlane16_swap_b32 v96, v108
    v_permlane16_swap_b32 v97, v109
    v_permlane16_swap_b32 v98, v110
    v_permlane16_swap_b32 v99, v111
    v_add_f32 v96, v96, v108
    v_add_f32 v97, v97, v109
    v_add_f32 v98, v98, v110
    v_add_f32 v99, v99, v111
    v_mul_f32 v6, 0x3b800000, v96
    v_mul_f32 v14, 0x3b800000, v97
    v_mul_f32 v22, 0x3b800000, v98
    v_mul_f32 v30, 0x3b800000, v99
    buffer_load_dwordx4 v[164:167], v107, s[40:43], s65 offen offset:1024
    v_pk_add_f32 v[0:1], v[32:33], v[6:7] op_sel_hi:[1,0] neg_lo:[0,1] neg_hi:[0,1]
    v_pk_add_f32 v[8:9], v[48:49], v[14:15] op_sel_hi:[1,0] neg_lo:[0,1] neg_hi:[0,1]
    v_pk_add_f32 v[16:17], v[64:65], v[22:23] op_sel_hi:[1,0] neg_lo:[0,1] neg_hi:[0,1]
    v_pk_add_f32 v[24:25], v[80:81], v[30:31] op_sel_hi:[1,0] neg_lo:[0,1] neg_hi:[0,1]
    v_pk_fma_f32 v[4:5], v[0:1], v[0:1], v[4:5]
    v_pk_fma_f32 v[12:13], v[8:9], v[8:9], v[12:13]
    v_pk_fma_f32 v[20:21], v[16:17], v[16:17], v[20:21]
    v_pk_fma_f32 v[28:29], v[24:25], v[24:25], v[28:29]
    v_pk_add_f32 v[0:1], v[34:35], v[6:7] op_sel_hi:[1,0] neg_lo:[0,1] neg_hi:[0,1]
    v_pk_add_f32 v[8:9], v[50:51], v[14:15] op_sel_hi:[1,0] neg_lo:[0,1] neg_hi:[0,1]
    v_pk_add_f32 v[16:17], v[66:67], v[22:23] op_sel_hi:[1,0] neg_lo:[0,1] neg_hi:[0,1]
    v_pk_add_f32 v[24:25], v[82:83], v[30:31] op_sel_hi:[1,0] neg_lo:[0,1] neg_hi:[0,1]
    v_pk_fma_f32 v[4:5], v[0:1], v[0:1], v[4:5]
    v_pk_fma_f32 v[12:13], v[8:9], v[8:9], v[12:13]
    v_pk_fma_f32 v[20:21], v[16:17], v[16:17], v[20:21]
    v_pk_fma_f32 v[28:29], v[24:25], v[24:25], v[28:29]
    v_pk_add_f32 v[0:1], v[36:37], v[6:7] op_sel_hi:[1,0] neg_lo:[0,1] neg_hi:[0,1]
    v_pk_add_f32 v[8:9], v[52:53], v[14:15] op_sel_hi:[1,0] neg_lo:[0,1] neg_hi:[0,1]
    v_pk_add_f32 v[16:17], v[68:69], v[22:23] op_sel_hi:[1,0] neg_lo:[0,1] neg_hi:[0,1]
    v_pk_add_f32 v[24:25], v[84:85], v[30:31] op_sel_hi:[1,0] neg_lo:[0,1] neg_hi:[0,1]
    v_pk_fma_f32 v[4:5], v[0:1], v[0:1], v[4:5]
    v_pk_fma_f32 v[12:13], v[8:9], v[8:9], v[12:13]
    v_pk_fma_f32 v[20:21], v[16:17], v[16:17], v[20:21]
    v_pk_fma_f32 v[28:29], v[24:25], v[24:25], v[28:29]
    v_pk_add_f32 v[0:1], v[38:39], v[6:7] op_sel_hi:[1,0] neg_lo:[0,1] neg_hi:[0,1]
    v_pk_add_f32 v[8:9], v[54:55], v[14:15] op_sel_hi:[1,0] neg_lo:[0,1] neg_hi:[0,1]
    v_pk_add_f32 v[16:17], v[70:71], v[22:23] op_sel_hi:[1,0] neg_lo:[0,1] neg_hi:[0,1]
    v_pk_add_f32 v[24:25], v[86:87], v[30:31] op_sel_hi:[1,0] neg_lo:[0,1] neg_hi:[0,1]
    v_pk_fma_f32 v[4:5], v[0:1], v[0:1], v[4:5]
    v_pk_fma_f32 v[12:13], v[8:9], v[8:9], v[12:13]
    v_pk_fma_f32 v[20:21], v[16:17], v[16:17], v[20:21]
    v_pk_fma_f32 v[28:29], v[24:25], v[24:25], v[28:29]
    v_add_f32 v100, v4, v5
    v_add_f32 v101, v12, v13
    v_add_f32 v102, v20, v21
    v_add_f32 v103, v28, v29
    v_add_f32 v100, v100, v100 row_ror:8
    v_add_f32 v101, v101, v101 row_ror:8
    v_add_f32 v102, v102, v102 row_ror:8
    v_add_f32 v103, v103, v103 row_ror:8
    buffer_load_dwordx4 v[168:171], v107, s[40:43], s65 offen offset:2048
    v_add_f32 v100, v100, v100 row_ror:4
    v_add_f32 v101, v101, v101 row_ror:4
    v_add_f32 v102, v102, v102 row_ror:4
    v_add_f32 v103, v103, v103 row_ror:4
    v_add_f32 v100, v100, v100 row_ror:2
    v_add_f32 v101, v101, v101 row_ror:2
    v_add_f32 v102, v102, v102 row_ror:2
    v_add_f32 v103, v103, v103 row_ror:2
    v_add_f32 v100, v100, v100 row_ror:1
    v_add_f32 v101, v101, v101 row_ror:1
    v_add_f32 v102, v102, v102 row_ror:1
    v_add_f32 v103, v103, v103 row_ror:1
    v_mov_b32 v108, v100
    v_mov_b32 v109, v101
    v_mov_b32 v110, v102
    v_mov_b32 v111, v103
    v_permlane16_swap_b32 v100, v108
    v_permlane16_swap_b32 v101, v109
    v_permlane16_swap_b32 v102, v110
    v_permlane16_swap_b32 v103, v111
    v_add_f32 v100, v100, v108
    v_add_f32 v101, v101, v109
    v_add_f32 v102, v102, v110
    v_add_f32 v103, v103, v111
    v_mul_f32 v100, 0x3a800000, v100
    v_mul_f32 v96, 0x3b000000, v96
    v_mul_f32 v101, 0x3a800000, v101
    v_mul_f32 v97, 0x3b000000, v97
    v_mul_f32 v102, 0x3a800000, v102
    v_mul_f32 v98, 0x3b000000, v98
    v_mul_f32 v103, 0x3a800000, v103
    v_mul_f32 v99, 0x3b000000, v99
    v_cvt_pk_bf16_f32 v100, v100, v100
    v_cvt_pk_bf16_f32 v101, v101, v101
    v_cvt_pk_bf16_f32 v102, v102, v102
    v_cvt_pk_bf16_f32 v103, v103, v103
    v_lshlrev_b32 v100, 16, v100
    v_lshlrev_b32 v101, 16, v101
    v_lshlrev_b32 v102, 16, v102
    v_lshlrev_b32 v103, 16, v103
    buffer_load_dwordx4 v[172:175], v107, s[40:43], s65 offen offset:3072
    v_add_f32 v100, 0x3727c5ac, v100
    v_add_f32 v101, 0x3727c5ac, v101
    v_add_f32 v102, 0x3727c5ac, v102
    v_add_f32 v103, 0x3727c5ac, v103
    v_cvt_pk_bf16_f32 v100, v100, v100
    v_cvt_pk_bf16_f32 v101, v101, v101
    v_cvt_pk_bf16_f32 v102, v102, v102
    v_cvt_pk_bf16_f32 v103, v103, v103
    v_lshlrev_b32 v100, 16, v100
    v_lshlrev_b32 v101, 16, v101
    v_lshlrev_b32 v102, 16, v102
    v_lshlrev_b32 v103, 16, v103
    v_sqrt_f32 v100, v100
    v_sqrt_f32 v101, v101
    v_sqrt_f32 v102, v102
    v_sqrt_f32 v103, v103
    v_cvt_pk_bf16_f32 v0, v96, v100
    v_cvt_pk_bf16_f32 v2, v97, v101
    v_cvt_pk_bf16_f32 v4, v98, v102
    v_cvt_pk_bf16_f32 v6, v99, v103
    s_waitcnt lgkmcnt(0)
    s_add_u32 s56, s56, 0x9E3779B1
    v_mov_b32 v1, s56
    v_and_b32 v100, 0xffff0000, v0
    v_rcp_f32 v100, v100
    v_lshlrev_b32 v96, 16, v0
    v_mov_b32 v3, s56
    v_and_b32 v101, 0xffff0000, v2
    v_rcp_f32 v101, v101
    v_lshlrev_b32 v97, 16, v2
    v_mov_b32 v5, s56
    v_and_b32 v102, 0xffff0000, v4
    v_rcp_f32 v102, v102
    v_lshlrev_b32 v98, 16, v4
    v_mov_b32 v7, s56
    v_and_b32 v103, 0xffff0000, v6
    v_rcp_f32 v103, v103
    v_lshlrev_b32 v99, 16, v6
    v_lshrrev_b32 v116, 5, v106
    v_lshlrev_b32 v125, 8, v116
    s_lshl_b32 s13, s2, 3
    s_lshl_b32 s14, s57, 11
    s_add_u32 s13, s13, s14
    s_add_u32 s13, s13, 0x10000
    s_mov_b32 exec_lo, 1
    s_mov_b32 exec_hi, 1
    buffer_store_dwordx2 v[0:1], v125, s[36:39], s13 offen offset:0 sc1
    buffer_store_dwordx2 v[2:3], v125, s[36:39], s13 offen offset:512 sc1
    buffer_store_dwordx2 v[4:5], v125, s[36:39], s13 offen offset:1024 sc1
    buffer_store_dwordx2 v[6:7], v125, s[36:39], s13 offen offset:1536 sc1
    s_mov_b64 exec, -1
    s_lshl_b32 s14, s57, 3
    v_add_u32 v116, s14, v116
    v_and_b32 v117, 31, v106
    v_mul_f32 v96, -2.0, v96
    v_mul_f32 v110, v96, v100
    v_mov_b32 v108, v100
    v_pk_fma_f32 v[32:33], v[32:33], v[108:109], v[110:111] op_sel_hi:[1,0,0]
    s_add_u32 s65, s65, 4096
    buffer_load_dwordx4 v[176:179], v107, s[40:43], s65 offen offset:0
    v_pk_mul_f32 v[40:41], v[40:41], v[108:109] op_sel_hi:[1,0]
    v_pk_fma_f32 v[34:35], v[34:35], v[108:109], v[110:111] op_sel_hi:[1,0,0]
    v_pk_mul_f32 v[42:43], v[42:43], v[108:109] op_sel_hi:[1,0]
    v_pk_fma_f32 v[36:37], v[36:37], v[108:109], v[110:111] op_sel_hi:[1,0,0]
    v_pk_mul_f32 v[44:45], v[44:45], v[108:109] op_sel_hi:[1,0]
    v_pk_fma_f32 v[38:39], v[38:39], v[108:109], v[110:111] op_sel_hi:[1,0,0]
    v_pk_mul_f32 v[46:47], v[46:47], v[108:109] op_sel_hi:[1,0]
    v_cvt_pk_bf16_f32 v32, v32, v33
    v_cvt_pk_bf16_f32 v33, v34, v35
    v_cvt_pk_bf16_f32 v34, v36, v37
    v_cvt_pk_bf16_f32 v35, v38, v39
    v_cvt_pk_bf16_f32 v36, v40, v41
    v_cvt_pk_bf16_f32 v37, v42, v43
    v_cvt_pk_bf16_f32 v38, v44, v45
    v_cvt_pk_bf16_f32 v39, v46, v47
    v_add_u32 v118, 0, v116
    v_and_b32 v119, 15, v118
    v_xor_b32 v119, v119, v117
    v_lshlrev_b32 v118, 9, v118
    v_lshl_add_u32 v118, v119, 4, v118
    ds_write_b128 v118, v[32:35] offset:0
    ds_write_b128 v118, v[36:39] offset:32768
    v_mul_f32 v97, -2.0, v97
    v_mul_f32 v110, v97, v101
    v_mov_b32 v108, v101
    v_pk_fma_f32 v[48:49], v[48:49], v[108:109], v[110:111] op_sel_hi:[1,0,0]
    v_pk_mul_f32 v[56:57], v[56:57], v[108:109] op_sel_hi:[1,0]
    v_pk_fma_f32 v[50:51], v[50:51], v[108:109], v[110:111] op_sel_hi:[1,0,0]
    v_pk_mul_f32 v[58:59], v[58:59], v[108:109] op_sel_hi:[1,0]
    v_pk_fma_f32 v[52:53], v[52:53], v[108:109], v[110:111] op_sel_hi:[1,0,0]
    v_pk_mul_f32 v[60:61], v[60:61], v[108:109] op_sel_hi:[1,0]
    v_pk_fma_f32 v[54:55], v[54:55], v[108:109], v[110:111] op_sel_hi:[1,0,0]
    v_pk_mul_f32 v[62:63], v[62:63], v[108:109] op_sel_hi:[1,0]
    v_cvt_pk_bf16_f32 v48, v48, v49
    v_cvt_pk_bf16_f32 v49, v50, v51
    v_cvt_pk_bf16_f32 v50, v52, v53
    v_cvt_pk_bf16_f32 v51, v54, v55
    v_cvt_pk_bf16_f32 v52, v56, v57
    v_cvt_pk_bf16_f32 v53, v58, v59
    v_cvt_pk_bf16_f32 v54, v60, v61
    buffer_load_dwordx4 v[180:183], v107, s[40:43], s65 offen offset:1024
    v_cvt_pk_bf16_f32 v55, v62, v63
    v_add_u32 v118, 2, v116
    v_and_b32 v119, 15, v118
    v_xor_b32 v119, v119, v117
    v_lshlrev_b32 v118, 9, v118
    v_lshl_add_u32 v118, v119, 4, v118
    ds_write_b128 v118, v[48:51] offset:0
    ds_write_b128 v118, v[52:55] offset:32768
    v_mul_f32 v98, -2.0, v98
    v_mul_f32 v110, v98, v102
    v_mov_b32 v108, v102
    v_pk_fma_f32 v[64:65], v[64:65], v[108:109], v[110:111] op_sel_hi:[1,0,0]
    v_pk_mul_f32 v[72:73], v[72:73], v[108:109] op_sel_hi:[1,0]
    v_pk_fma_f32 v[66:67], v[66:67], v[108:109], v[110:111] op_sel_hi:[1,0,0]
    v_pk_mul_f32 v[74:75], v[74:75], v[108:109] op_sel_hi:[1,0]
    v_pk_fma_f32 v[68:69], v[68:69], v[108:109], v[110:111] op_sel_hi:[1,0,0]
    v_pk_mul_f32 v[76:77], v[76:77], v[108:109] op_sel_hi:[1,0]
    v_pk_fma_f32 v[70:71], v[70:71], v[108:109], v[110:111] op_sel_hi:[1,0,0]
    v_pk_mul_f32 v[78:79], v[78:79], v[108:109] op_sel_hi:[1,0]
    v_cvt_pk_bf16_f32 v64, v64, v65
    v_cvt_pk_bf16_f32 v65, v66, v67
    v_cvt_pk_bf16_f32 v66, v68, v69
    v_cvt_pk_bf16_f32 v67, v70, v71
    v_cvt_pk_bf16_f32 v68, v72, v73
    v_cvt_pk_bf16_f32 v69, v74, v75
    v_cvt_pk_bf16_f32 v70, v76, v77
    v_cvt_pk_bf16_f32 v71, v78, v79
    v_add_u32 v118, 4, v116
    v_and_b32 v119, 15, v118
    v_xor_b32 v119, v119, v117
    v_lshlrev_b32 v118, 9, v118
    v_lshl_add_u32 v118, v119, 4, v118
    ds_write_b128 v118, v[64:67] offset:0
    ds_write_b128 v118, v[68:71] offset:32768
    v_mul_f32 v99, -2.0, v99
    v_mul_f32 v110, v99, v103
    v_mov_b32 v108, v103
    v_pk_fma_f32 v[80:81], v[80:81], v[108:109], v[110:111] op_sel_hi:[1,0,0]
    v_pk_mul_f32 v[88:89], v[88:89], v[108:109] op_sel_hi:[1,0]
    v_pk_fma_f32 v[82:83], v[82:83], v[108:109], v[110:111] op_sel_hi:[1,0,0]
    buffer_load_dwordx4 v[184:187], v107, s[40:43], s65 offen offset:2048
    v_pk_mul_f32 v[90:91], v[90:91], v[108:109] op_sel_hi:[1,0]
    v_pk_fma_f32 v[84:85], v[84:85], v[108:109], v[110:111] op_sel_hi:[1,0,0]
    v_pk_mul_f32 v[92:93], v[92:93], v[108:109] op_sel_hi:[1,0]
    v_pk_fma_f32 v[86:87], v[86:87], v[108:109], v[110:111] op_sel_hi:[1,0,0]
    v_pk_mul_f32 v[94:95], v[94:95], v[108:109] op_sel_hi:[1,0]
    v_cvt_pk_bf16_f32 v80, v80, v81
    v_cvt_pk_bf16_f32 v81, v82, v83
    v_cvt_pk_bf16_f32 v82, v84, v85
    v_cvt_pk_bf16_f32 v83, v86, v87
    v_cvt_pk_bf16_f32 v84, v88, v89
    v_cvt_pk_bf16_f32 v85, v90, v91
    v_cvt_pk_bf16_f32 v86, v92, v93
    v_cvt_pk_bf16_f32 v87, v94, v95
    v_add_u32 v118, 6, v116
    v_and_b32 v119, 15, v118
    v_xor_b32 v119, v119, v117
    v_lshlrev_b32 v118, 9, v118
    v_lshl_add_u32 v118, v119, 4, v118
    ds_write_b128 v118, v[80:83] offset:0
    ds_write_b128 v118, v[84:87] offset:32768
    v_and_b32 v116, 31, v106
    v_and_b32 v117, 15, v106
    v_lshrrev_b32 v118, 5, v106
    v_xor_b32 v117, v117, v118
    v_lshlrev_b32 v116, 9, v116
    s_lshr_b32 s12, s57, 2
    s_lshl_b32 s12, s12, 15
    v_add_u32 v116, s12, v116
    v_xor_b32 v118, 0, v117
    v_lshl_add_u32 v96, v118, 4, v116
    v_xor_b32 v118, 2, v117
    v_lshl_add_u32 v97, v118, 4, v116
    v_xor_b32 v118, 4, v117
    v_lshl_add_u32 v98, v118, 4, v116
    v_xor_b32 v118, 6, v117
    v_lshl_add_u32 v99, v118, 4, v116
    v_xor_b32 v118, 8, v117
    v_lshl_add_u32 v100, v118, 4, v116
    v_xor_b32 v118, 10, v117
    v_lshl_add_u32 v101, v118, 4, v116
    v_xor_b32 v118, 12, v117
    v_lshl_add_u32 v102, v118, 4, v116
    v_xor_b32 v118, 14, v117
    v_lshl_add_u32 v103, v118, 4, v116
    s_waitcnt lgkmcnt(0)
    s_barrier
    s_mul_i32 s13, s57, 270336
    s_lshl_b32 s14, s2, 7
    s_add_u32 s13, s13, s14
    s_add_u32 s13, s13, 0xe00000
    s_mul_i32 s14, s57, 4608
    s_add_u32 s14, s14, 81920
    v_and_b32 v116, 31, v106
    v_mul_u32_u24 v116, 144, v116
    v_lshrrev_b32 v117, 5, v106
    v_lshl_add_u32 v116, v117, 4, v116
    v_add_u32 v104, s14, v116
    v_lshrrev_b32 v116, 3, v106
    v_and_b32 v117, 7, v106
    v_lshlrev_b32 v117, 4, v117
    v_mul_u32_u24 v118, 144, v116
    v_add3_u32 v105, v118, v117, s14
    v_mul_u32_u24 v118, 4224, v116
    v_add_u32 v126, v118, v117
    ds_read_b128 v[80:83], v96 offset:0
    ds_read_b128 v[84:87], v96 offset:16384
    ds_read_b128 v[88:91], v97 offset:0
    ds_read_b128 v[92:95], v97 offset:16384
    s_waitcnt vmcnt(18) lgkmcnt(2)
    ds_read_b128 v[8:11], v98 offset:0
    ds_read_b128 v[12:15], v98 offset:16384
    v_mfma_f32_32x32x16_bf16 v[16:31], v[80:83], v[128:131], 0
    v_mfma_f32_32x32x16_bf16 v[32:47], v[84:87], v[128:131], 0
    buffer_load_dwordx4 v[188:191], v107, s[40:43], s65 offen offset:3072
    s_waitcnt vmcnt(18) lgkmcnt(2)
    ds_read_b128 v[80:83], v99 offset:0
    ds_read_b128 v[84:87], v99 offset:16384
    v_mfma_f32_32x32x16_bf16 v[16:31], v[88:91], v[132:135], v[16:31]
    v_mfma_f32_32x32x16_bf16 v[32:47], v[92:95], v[132:135], v[32:47]
    s_add_u32 s65, s65, 4096
    buffer_load_dwordx4 v[192:195], v107, s[40:43], s65 offen offset:0
    s_waitcnt vmcnt(18) lgkmcnt(2)
    ds_read_b128 v[88:91], v100 offset:0
    ds_read_b128 v[92:95], v100 offset:16384
    v_mfma_f32_32x32x16_bf16 v[16:31], v[8:11], v[136:139], v[16:31]
    v_mfma_f32_32x32x16_bf16 v[32:47], v[12:15], v[136:139], v[32:47]
    buffer_load_dwordx4 v[196:199], v107, s[40:43], s65 offen offset:1024
    s_waitcnt vmcnt(18) lgkmcnt(2)
    ds_read_b128 v[8:11], v101 offset:0
    ds_read_b128 v[12:15], v101 offset:16384
    v_mfma_f32_32x32x16_bf16 v[16:31], v[80:83], v[140:143], v[16:31]
    v_mfma_f32_32x32x16_bf16 v[32:47], v[84:87], v[140:143], v[32:47]
    buffer_load_dwordx4 v[200:203], v107, s[40:43], s65 offen offset:2048
    s_waitcnt vmcnt(18) lgkmcnt(2)
    ds_read_b128 v[80:83], v102 offset:0
    ds_read_b128 v[84:87], v102 offset:16384
    v_mfma_f32_32x32x16_bf16 v[16:31], v[88:91], v[144:147], v[16:31]
    v_mfma_f32_32x32x16_bf16 v[32:47], v[92:95], v[144:147], v[32:47]
    buffer_load_dwordx4 v[204:207], v107, s[40:43], s65 offen offset:3072
    s_waitcnt vmcnt(18) lgkmcnt(2)
    ds_read_b128 v[88:91], v103 offset:0
    ds_read_b128 v[92:95], v103 offset:16384
    v_mfma_f32_32x32x16_bf16 v[16:31], v[8:11], v[148:151], v[16:31]
    v_mfma_f32_32x32x16_bf16 v[32:47], v[12:15], v[148:151], v[32:47]
    s_add_u32 s65, s65, 4096
    buffer_load_dwordx4 v[208:211], v107, s[40:43], s65 offen offset:0
    s_waitcnt vmcnt(18) lgkmcnt(2)
    ds_read_b128 v[8:11], v96 offset:256
    ds_read_b128 v[12:15], v96 offset:16640
    v_mfma_f32_32x32x16_bf16 v[16:31], v[80:83], v[152:155], v[16:31]
    v_mfma_f32_32x32x16_bf16 v[32:47], v[84:87], v[152:155], v[32:47]
    buffer_load_dwordx4 v[212:215], v107, s[40:43], s65 offen offset:1024
    s_waitcnt vmcnt(18) lgkmcnt(2)
    ds_read_b128 v[80:83], v97 offset:256
    ds_read_b128 v[84:87], v97 offset:16640
    v_mfma_f32_32x32x16_bf16 v[16:31], v[88:91], v[156:159], v[16:31]
    v_mfma_f32_32x32x16_bf16 v[32:47], v[92:95], v[156:159], v[32:47]
    buffer_load_dwordx4 v[216:219], v107, s[40:43], s65 offen offset:2048
    s_waitcnt vmcnt(18) lgkmcnt(2)
    ds_read_b128 v[88:91], v98 offset:256
    ds_read_b128 v[92:95], v98 offset:16640
    v_mfma_f32_32x32x16_bf16 v[16:31], v[8:11], v[160:163], v[16:31]
    v_mfma_f32_32x32x16_bf16 v[32:47], v[12:15], v[160:163], v[32:47]
    buffer_load_dwordx4 v[220:223], v107, s[40:43], s65 offen offset:3072
    s_waitcnt vmcnt(18) lgkmcnt(2)
    ds_read_b128 v[8:11], v99 offset:256
    ds_read_b128 v[12:15], v99 offset:16640
    v_mfma_f32_32x32x16_bf16 v[16:31], v[80:83], v[164:167], v[16:31]
    v_mfma_f32_32x32x16_bf16 v[32:47], v[84:87], v[164:167], v[32:47]
    s_add_u32 s65, s65, 4096
    buffer_load_dwordx4 v[224:227], v107, s[40:43], s65 offen offset:0
    s_waitcnt vmcnt(18) lgkmcnt(2)
    ds_read_b128 v[80:83], v100 offset:256
    ds_read_b128 v[84:87], v100 offset:16640
    v_mfma_f32_32x32x16_bf16 v[16:31], v[88:91], v[168:171], v[16:31]
    v_mfma_f32_32x32x16_bf16 v[32:47], v[92:95], v[168:171], v[32:47]
    buffer_load_dwordx4 v[228:231], v107, s[40:43], s65 offen offset:1024
    s_waitcnt vmcnt(18) lgkmcnt(2)
    ds_read_b128 v[88:91], v101 offset:256
    ds_read_b128 v[92:95], v101 offset:16640
    v_mfma_f32_32x32x16_bf16 v[16:31], v[8:11], v[172:175], v[16:31]
    v_mfma_f32_32x32x16_bf16 v[32:47], v[12:15], v[172:175], v[32:47]
    buffer_load_dwordx4 v[232:235], v107, s[40:43], s65 offen offset:2048
    s_waitcnt vmcnt(14) lgkmcnt(2)
    ds_read_b128 v[8:11], v102 offset:256
    ds_read_b128 v[12:15], v102 offset:16640
    v_mfma_f32_32x32x16_bf16 v[16:31], v[80:83], v[176:179], v[16:31]
    v_mfma_f32_32x32x16_bf16 v[32:47], v[84:87], v[176:179], v[32:47]
    buffer_load_dwordx4 v[236:239], v107, s[40:43], s65 offen offset:3072
    s_waitcnt vmcnt(14) lgkmcnt(2)
    ds_read_b128 v[80:83], v103 offset:256
    ds_read_b128 v[84:87], v103 offset:16640
    v_mfma_f32_32x32x16_bf16 v[16:31], v[88:91], v[180:183], v[16:31]
    v_mfma_f32_32x32x16_bf16 v[32:47], v[92:95], v[180:183], v[32:47]
    s_add_u32 s65, s65, 4096
    buffer_load_dwordx4 v[240:243], v107, s[40:43], s65 offen offset:0
    s_waitcnt vmcnt(14) lgkmcnt(2)
    ds_read_b128 v[88:91], v96 offset:0
    ds_read_b128 v[92:95], v96 offset:16384
    v_mfma_f32_32x32x16_bf16 v[16:31], v[8:11], v[184:187], v[16:31]
    v_mfma_f32_32x32x16_bf16 v[32:47], v[12:15], v[184:187], v[32:47]
    buffer_load_dwordx4 v[244:247], v107, s[40:43], s65 offen offset:1024
    s_waitcnt vmcnt(14) lgkmcnt(2)
    ds_read_b128 v[8:11], v97 offset:0
    ds_read_b128 v[12:15], v97 offset:16384
    v_mfma_f32_32x32x16_bf16 v[16:31], v[80:83], v[188:191], v[16:31]
    v_mfma_f32_32x32x16_bf16 v[32:47], v[84:87], v[188:191], v[32:47]
    buffer_load_dwordx4 v[248:251], v107, s[40:43], s65 offen offset:2048
    s_waitcnt vmcnt(14) lgkmcnt(2)
    ds_read_b128 v[80:83], v98 offset:0
    ds_read_b128 v[84:87], v98 offset:16384
    v_mfma_f32_32x32x16_bf16 v[48:63], v[88:91], v[192:195], 0
    v_mfma_f32_32x32x16_bf16 v[64:79], v[92:95], v[192:195], 0
    buffer_load_dwordx4 v[252:255], v107, s[40:43], s65 offen offset:3072
    s_waitcnt vmcnt(14) lgkmcnt(2)
    ds_read_b128 v[88:91], v99 offset:0
    ds_read_b128 v[92:95], v99 offset:16384
    v_mfma_f32_32x32x16_bf16 v[48:63], v[8:11], v[196:199], v[48:63]
    v_mfma_f32_32x32x16_bf16 v[64:79], v[12:15], v[196:199], v[64:79]
    v_cvt_pk_bf16_f32 v16, v16, v17
    v_cvt_pk_bf16_f32 v17, v18, v19
    v_cvt_pk_bf16_f32 v18, v20, v21
    v_cvt_pk_bf16_f32 v19, v22, v23
    ds_write_b128 v104, v[16:19] offset:0
    s_waitcnt vmcnt(13) lgkmcnt(0)
    ds_read_b128 v[8:11], v100 offset:0
    ds_read_b128 v[12:15], v100 offset:16384
    v_mfma_f32_32x32x16_bf16 v[48:63], v[80:83], v[200:203], v[48:63]
    v_mfma_f32_32x32x16_bf16 v[64:79], v[84:87], v[200:203], v[64:79]
    v_cvt_pk_bf16_f32 v24, v24, v25
    v_cvt_pk_bf16_f32 v25, v26, v27
    v_cvt_pk_bf16_f32 v26, v28, v29
    v_cvt_pk_bf16_f32 v27, v30, v31
    ds_write_b128 v104, v[24:27] offset:32
    s_waitcnt vmcnt(12) lgkmcnt(0)
    ds_read_b128 v[80:83], v101 offset:0
    ds_read_b128 v[84:87], v101 offset:16384
    v_mfma_f32_32x32x16_bf16 v[48:63], v[88:91], v[204:207], v[48:63]
    v_mfma_f32_32x32x16_bf16 v[64:79], v[92:95], v[204:207], v[64:79]
    v_cvt_pk_bf16_f32 v32, v32, v33
    v_cvt_pk_bf16_f32 v33, v34, v35
    v_cvt_pk_bf16_f32 v34, v36, v37
    v_cvt_pk_bf16_f32 v35, v38, v39
    ds_write_b128 v104, v[32:35] offset:64
    s_waitcnt vmcnt(11) lgkmcnt(0)
    ds_read_b128 v[88:91], v102 offset:0
    ds_read_b128 v[92:95], v102 offset:16384
    v_mfma_f32_32x32x16_bf16 v[48:63], v[8:11], v[208:211], v[48:63]
    v_mfma_f32_32x32x16_bf16 v[64:79], v[12:15], v[208:211], v[64:79]
    v_cvt_pk_bf16_f32 v40, v40, v41
    v_cvt_pk_bf16_f32 v41, v42, v43
    v_cvt_pk_bf16_f32 v42, v44, v45
    v_cvt_pk_bf16_f32 v43, v46, v47
    ds_write_b128 v104, v[40:43] offset:96
    s_waitcnt vmcnt(10) lgkmcnt(0)
    ds_read_b128 v[8:11], v103 offset:0
    ds_read_b128 v[12:15], v103 offset:16384
    v_mfma_f32_32x32x16_bf16 v[48:63], v[80:83], v[212:215], v[48:63]
    v_mfma_f32_32x32x16_bf16 v[64:79], v[84:87], v[212:215], v[64:79]
    ds_read_b128 v[20:23], v105 offset:0
    ds_read_b128 v[28:31], v105 offset:1152
    ds_read_b128 v[36:39], v105 offset:2304
    ds_read_b128 v[44:47], v105 offset:3456
    s_waitcnt vmcnt(9) lgkmcnt(0)
    ds_read_b128 v[80:83], v96 offset:256
    ds_read_b128 v[84:87], v96 offset:16640
    v_mfma_f32_32x32x16_bf16 v[48:63], v[88:91], v[216:219], v[48:63]
    v_mfma_f32_32x32x16_bf16 v[64:79], v[92:95], v[216:219], v[64:79]
    buffer_store_dwordx4 v[20:23], v126, s[36:39], s13 offen sc1
    s_add_u32 s13, s13, 33792
    s_waitcnt vmcnt(9) lgkmcnt(2)
    ds_read_b128 v[88:91], v97 offset:256
    ds_read_b128 v[92:95], v97 offset:16640
    v_mfma_f32_32x32x16_bf16 v[48:63], v[8:11], v[220:223], v[48:63]
    v_mfma_f32_32x32x16_bf16 v[64:79], v[12:15], v[220:223], v[64:79]
    buffer_store_dwordx4 v[28:31], v126, s[36:39], s13 offen sc1
    s_add_u32 s13, s13, 33792
    s_waitcnt vmcnt(9) lgkmcnt(2)
    ds_read_b128 v[8:11], v98 offset:256
    ds_read_b128 v[12:15], v98 offset:16640
    v_mfma_f32_32x32x16_bf16 v[48:63], v[80:83], v[224:227], v[48:63]
    v_mfma_f32_32x32x16_bf16 v[64:79], v[84:87], v[224:227], v[64:79]
    buffer_store_dwordx4 v[36:39], v126, s[36:39], s13 offen sc1
    s_add_u32 s13, s13, 33792
    s_waitcnt vmcnt(9) lgkmcnt(2)
    ds_read_b128 v[80:83], v99 offset:256
    ds_read_b128 v[84:87], v99 offset:16640
    v_mfma_f32_32x32x16_bf16 v[48:63], v[88:91], v[228:231], v[48:63]
    v_mfma_f32_32x32x16_bf16 v[64:79], v[92:95], v[228:231], v[64:79]
    buffer_store_dwordx4 v[44:47], v126, s[36:39], s13 offen sc1
    s_add_u32 s13, s13, 33792
    s_waitcnt vmcnt(9) lgkmcnt(2)
    ds_read_b128 v[88:91], v100 offset:256
    ds_read_b128 v[92:95], v100 offset:16640
    v_mfma_f32_32x32x16_bf16 v[48:63], v[8:11], v[232:235], v[48:63]
    v_mfma_f32_32x32x16_bf16 v[64:79], v[12:15], v[232:235], v[64:79]
    s_waitcnt vmcnt(8) lgkmcnt(2)
    ds_read_b128 v[8:11], v101 offset:256
    ds_read_b128 v[12:15], v101 offset:16640
    v_mfma_f32_32x32x16_bf16 v[48:63], v[80:83], v[236:239], v[48:63]
    v_mfma_f32_32x32x16_bf16 v[64:79], v[84:87], v[236:239], v[64:79]
    s_waitcnt vmcnt(7) lgkmcnt(2)
    ds_read_b128 v[80:83], v102 offset:256
    ds_read_b128 v[84:87], v102 offset:16640
    v_mfma_f32_32x32x16_bf16 v[48:63], v[88:91], v[240:243], v[48:63]
    v_mfma_f32_32x32x16_bf16 v[64:79], v[92:95], v[240:243], v[64:79]
    s_waitcnt vmcnt(6) lgkmcnt(2)
    ds_read_b128 v[88:91], v103 offset:256
    ds_read_b128 v[92:95], v103 offset:16640
    v_mfma_f32_32x32x16_bf16 v[48:63], v[8:11], v[244:247], v[48:63]
    v_mfma_f32_32x32x16_bf16 v[64:79], v[12:15], v[244:247], v[64:79]
    s_waitcnt vmcnt(5) lgkmcnt(2)
    v_mfma_f32_32x32x16_bf16 v[48:63], v[80:83], v[248:251], v[48:63]
    v_mfma_f32_32x32x16_bf16 v[64:79], v[84:87], v[248:251], v[64:79]
    s_waitcnt vmcnt(4) lgkmcnt(0)
    v_mfma_f32_32x32x16_bf16 v[48:63], v[88:91], v[252:255], v[48:63]
    v_mfma_f32_32x32x16_bf16 v[64:79], v[92:95], v[252:255], v[64:79]
    s_nop 10
    v_cvt_pk_bf16_f32 v48, v48, v49
    v_cvt_pk_bf16_f32 v49, v50, v51
    v_cvt_pk_bf16_f32 v50, v52, v53
    v_cvt_pk_bf16_f32 v51, v54, v55
    ds_write_b128 v104, v[48:51] offset:0
    v_cvt_pk_bf16_f32 v56, v56, v57
    v_cvt_pk_bf16_f32 v57, v58, v59
    v_cvt_pk_bf16_f32 v58, v60, v61
    v_cvt_pk_bf16_f32 v59, v62, v63
    ds_write_b128 v104, v[56:59] offset:32
    v_cvt_pk_bf16_f32 v64, v64, v65
    v_cvt_pk_bf16_f32 v65, v66, v67
    v_cvt_pk_bf16_f32 v66, v68, v69
    v_cvt_pk_bf16_f32 v67, v70, v71
    ds_write_b128 v104, v[64:67] offset:64
    v_cvt_pk_bf16_f32 v72, v72, v73
    v_cvt_pk_bf16_f32 v73, v74, v75
    v_cvt_pk_bf16_f32 v74, v76, v77
    v_cvt_pk_bf16_f32 v75, v78, v79
    ds_write_b128 v104, v[72:75] offset:96
    ds_read_b128 v[52:55], v105 offset:0
    ds_read_b128 v[60:63], v105 offset:1152
    ds_read_b128 v[68:71], v105 offset:2304
    ds_read_b128 v[76:79], v105 offset:3456
    s_waitcnt lgkmcnt(3)
    buffer_store_dwordx4 v[52:55], v126, s[36:39], s13 offen sc1
    s_add_u32 s13, s13, 33792
    s_waitcnt lgkmcnt(2)
    buffer_store_dwordx4 v[60:63], v126, s[36:39], s13 offen sc1
    s_add_u32 s13, s13, 33792
    s_waitcnt lgkmcnt(1)
    buffer_store_dwordx4 v[68:71], v126, s[36:39], s13 offen sc1
    s_add_u32 s13, s13, 33792
    s_waitcnt lgkmcnt(0)
    buffer_store_dwordx4 v[76:79], v126, s[36:39], s13 offen sc1
    s_add_u32 s13, s13, 33792
    s_lshl_b32 s5, s2, 7
    s_add_u32 s5, s5, 0x30000
    s_cmp_lg_u32 s57, 0
    s_cselect_b32 s5, 0x7000000, s5
    s_cmp_lg_u32 s57, 0
    s_cbranch_scc1 L_A_NOW
    s_mul_i32 s9, s2, 896
    s_add_u32 s9, s9, 0x33000
    v_min_u32 v118, 6, v106
    v_lshlrev_b32 v118, 7, v118
    s_mov_b32 s6, 0
L_POLL_AW:
    buffer_load_dword v119, v118, s[36:39], s9 offen sc1
    s_add_u32 s6, s6, 1
    s_cmp_gt_u32 s6, 0x8000
    s_waitcnt vmcnt(0)
    s_cbranch_scc1 L_POLLED_AW
    v_cmp_ne_u32 vcc, s56, v119
    s_cbranch_vccz L_POLLED_AW
    s_mov_b64 exec, vcc
    s_sleep 4
    s_branch L_POLL_AW
L_POLLED_AW:
    s_mov_b64 exec, -1
L_A_NOW:
    s_waitcnt vmcnt(0)
    s_barrier
    v_mov_b32 v116, 0
    v_mov_b32 v117, s56
    s_mov_b64 exec, 1
    buffer_store_dword v117, v116, s[36:39], s5 offen sc1
    s_mov_b64 exec, -1
    s_mov_b32 s5, 0x7000000
    s_mov_b32 s64, 0x7000000
    s_mov_b32 s65, 0x7000000
    s_cmp_ge_u32 s57, 4
    s_cbranch_scc1 L_A_F
    v_mov_b32 v104, 162816
    v_mov_b32 v105, 1
    s_mov_b64 exec, 1
    ds_add_u32 v104, v105 offset:12
    s_mov_b64 exec, -1
    s_lshl_b32 s17, s58, 13
    s_lshl_b32 s18, s58, 14
    s_lshr_b32 s19, s62, 2
    s_lshl_b32 s19, s19, 7
    s_add_u32 s18, s18, s19
    v_lshrrev_b32 v116, 3, v106
    v_bfe_u32 v117, v106, 2, 1
    v_bfe_u32 v118, v106, 4, 1
    v_xor_b32 v117, v117, v118
    v_lshlrev_b32 v117, 6, v117
    v_and_b32 v118, 3, v106
    v_lshl_add_u32 v117, v118, 4, v117
    v_lshl_add_u32 v120, v116, 10, v117
    v_add_u32 v121, 7168, v120
    v_bfe_u32 v117, v106, 2, 2
    v_lshrrev_b32 v118, 5, v106
    v_lshl_add_u32 v118, v118, 2, v117
    v_lshlrev_b32 v118, 7, v118
    v_bfe_u32 v119, v106, 3, 1
    v_lshl_add_u32 v119, v119, 6, v118
    v_bfe_u32 v117, v106, 4, 1
    v_lshl_add_u32 v119, v117, 5, v119
    v_and_b32 v117, 3, v106
    v_lshl_add_u32 v119, v117, 3, v119
    s_and_b32 s7, s58, 2
    s_lshl_b32 s7, s7, 5
    v_xor_b32 v119, s7, v119
    v_add_u32 v119, s17, v119
    v_add_u32 v122, 32768, v119
    v_xor_b32 v123, 64, v122
    v_add_u32 v124, 65536, v122
    v_xor_b32 v125, 64, v124
    s_lshl_b32 s8, s61, 2
    s_and_b32 s9, s62, 3
    s_add_u32 s8, s8, s9
    s_mul_i32 s10, s8, 224
    s_add_u32 s10, s10, s58
    s_lshl_b32 s10, s10, 10
    s_add_u32 s10, s10, 0x600000
    s_and_b32 s7, s58, 1
    s_mul_i32 s7, s7, 114688
    s_sub_u32 s11, s10, s7
    s_add_u32 s11, s11, 114688
    s_add_u32 s10, s10, s7
    s_lshr_b32 s9, s8, 1
    s_lshl_b32 s9, s9, 11
    s_add_u32 s9, s9, 0x60000
    s_lshl_b32 s16, s8, 13
    s_lshr_b32 s7, s58, 1
    s_lshl_b32 s7, s7, 12
    s_add_u32 s16, s16, s7
    s_add_u32 s16, s16, 0x80000
    v_min_u32 v126, 27, v106
    v_lshlrev_b32 v126, 7, v126
    s_lshl_b32 s12, s8, 16
    s_and_b32 s7, s58, 1
    s_lshl_b32 s7, s7, 15
    s_add_u32 s12, s12, s7
    s_add_u32 s12, s12, s19
    s_lshr_b32 s7, s58, 1
    s_lshl_b32 s7, s7, 6
    s_add_u32 s12, s12, s7
    v_lshrrev_b32 v116, 2, v106
    v_lshlrev_b32 v116, 10, v116
    v_and_b32 v117, 3, v106
    v_lshl_add_u32 v116, v117, 4, v116
    s_add_u32 m0, s17, 131072
    s_add_u32 s7, s12, 15360
    buffer_load_dwordx4 v116, s[24:27], s12 offen lds
    buffer_load_dwordx4 v116, s[24:27], s7 offen offset:1024 lds
    s_add_u32 m0, s17, 98304
    s_add_u32 s19, s18, 0
    buffer_load_dwordx4 v120, s[44:47], s19 offen lds
    buffer_load_dwordx4 v121, s[44:47], s19 offen offset:1024 lds
    s_add_u32 m0, s17, 100352
    s_add_u32 s19, s18, 131072
    buffer_load_dwordx4 v120, s[44:47], s19 offen lds
    buffer_load_dwordx4 v121, s[44:47], s19 offen offset:1024 lds
    s_add_u32 m0, s17, 102400
    s_add_u32 s19, s18, 262144
    buffer_load_dwordx4 v120, s[44:47], s19 offen lds
    buffer_load_dwordx4 v121, s[44:47], s19 offen offset:1024 lds
    s_add_u32 m0, s17, 32768
    s_add_u32 s19, s18, 786432
    buffer_load_dwordx4 v120, s[44:47], s19 offen lds
    buffer_load_dwordx4 v121, s[44:47], s19 offen offset:1024 lds
    s_add_u32 m0, s17, 34816
    s_add_u32 s19, s18, 917504
    buffer_load_dwordx4 v120, s[44:47], s19 offen lds
    buffer_load_dwordx4 v121, s[44:47], s19 offen offset:1024 lds
    s_add_u32 m0, s17, 36864
    s_add_u32 s19, s18, 1048576
    buffer_load_dwordx4 v120, s[44:47], s19 offen lds
    buffer_load_dwordx4 v121, s[44:47], s19 offen offset:1024 lds
    s_add_u32 m0, s17, 38912
    s_add_u32 s19, s18, 1179648
    buffer_load_dwordx4 v120, s[44:47], s19 offen lds
    buffer_load_dwordx4 v121, s[44:47], s19 offen offset:1024 lds
    s_add_u32 m0, s17, 65536
    s_add_u32 s19, s18, 1310720
    buffer_load_dwordx4 v120, s[44:47], s19 offen lds
    buffer_load_dwordx4 v121, s[44:47], s19 offen offset:1024 lds
    s_add_u32 m0, s17, 67584
    s_add_u32 s19, s18, 1441792
    buffer_load_dwordx4 v120, s[44:47], s19 offen lds
    buffer_load_dwordx4 v121, s[44:47], s19 offen offset:1024 lds
    s_add_u32 m0, s17, 69632
    s_add_u32 s19, s18, 1572864
    buffer_load_dwordx4 v120, s[44:47], s19 offen lds
    buffer_load_dwordx4 v121, s[44:47], s19 offen offset:1024 lds
    s_add_u32 m0, s17, 71680
    s_add_u32 s19, s18, 1703936
    buffer_load_dwordx4 v120, s[44:47], s19 offen lds
    buffer_load_dwordx4 v121, s[44:47], s19 offen offset:1024 lds
    v_and_b32 v116, 31, v106
    v_lshlrev_b32 v116, 6, v116
    v_lshrrev_b32 v117, 5, v106
    v_lshl_add_u32 v116, v117, 3, v116
    s_add_u32 s7, s17, 131072
    v_add_u32 v116, s7, v116
    s_waitcnt vmcnt(22)
    ds_read_b64 v[16:17], v116 offset:0
    ds_read_b64 v[18:19], v116 offset:16
    ds_read_b64 v[20:21], v116 offset:32
    ds_read_b64 v[22:23], v116 offset:48
    s_waitcnt lgkmcnt(0)
    v_lshlrev_b32 v0, 16, v16
    v_and_b32 v1, 0xffff0000, v16
    v_lshlrev_b32 v2, 16, v17
    v_and_b32 v3, 0xffff0000, v17
    v_lshlrev_b32 v4, 16, v18
    v_and_b32 v5, 0xffff0000, v18
    v_lshlrev_b32 v6, 16, v19
    v_and_b32 v7, 0xffff0000, v19
    v_lshlrev_b32 v8, 16, v20
    v_and_b32 v9, 0xffff0000, v20
    v_lshlrev_b32 v10, 16, v21
    v_and_b32 v11, 0xffff0000, v21
    v_lshlrev_b32 v12, 16, v22
    v_and_b32 v13, 0xffff0000, v22
    v_lshlrev_b32 v14, 16, v23
    v_and_b32 v15, 0xffff0000, v23
    s_mov_b32 s6, 0
L_LW_AX:
    ds_read_b32 v116, v104 offset:28
    s_add_u32 s6, s6, 1
    s_waitcnt lgkmcnt(0)
    v_readfirstlane_b32 s7, v116
    s_cmp_gt_u32 s6, 0x40000
    s_cbranch_scc1 L_LWD_AX
    s_cmp_ge_u32 s7, 4
    s_cbranch_scc1 L_LWD_AX
    s_sleep 3
    s_branch L_LW_AX
L_LWD_AX:
    s_add_u32 m0, s17, 131072
    s_add_u32 s19, s18, 65536
    buffer_load_dwordx4 v120, s[44:47], s19 offen lds
    buffer_load_dwordx4 v121, s[44:47], s19 offen offset:1024 lds
    s_add_u32 m0, s17, 133120
    s_add_u32 s19, s18, 196608
    buffer_load_dwordx4 v120, s[44:47], s19 offen lds
    buffer_load_dwordx4 v121, s[44:47], s19 offen offset:1024 lds
    s_add_u32 m0, s17, 135168
    s_add_u32 s19, s18, 327680
    buffer_load_dwordx4 v120, s[44:47], s19 offen lds
    buffer_load_dwordx4 v121, s[44:47], s19 offen offset:1024 lds
    s_waitcnt vmcnt(4)
    ds_read_b64_tr_b16 v[144:145], v124 offset:32768
    ds_read_b64_tr_b16 v[146:147], v124 offset:33792
    ds_read_b64_tr_b16 v[148:149], v125 offset:32768
    ds_read_b64_tr_b16 v[150:151], v125 offset:33792
    s_waitcnt vmcnt(2)
    ds_read_b64_tr_b16 v[152:153], v124 offset:34816
    ds_read_b64_tr_b16 v[154:155], v124 offset:35840
    ds_read_b64_tr_b16 v[156:157], v125 offset:34816
    ds_read_b64_tr_b16 v[158:159], v125 offset:35840
    s_waitcnt vmcnt(0)
    ds_read_b64_tr_b16 v[160:161], v124 offset:36864
    ds_read_b64_tr_b16 v[162:163], v124 offset:37888
    ds_read_b64_tr_b16 v[164:165], v125 offset:36864
    ds_read_b64_tr_b16 v[166:167], v125 offset:37888
    s_waitcnt lgkmcnt(0)
    s_add_u32 m0, s17, 131072
    s_add_u32 s19, s18, 393216
    buffer_load_dwordx4 v120, s[44:47], s19 offen lds
    buffer_load_dwordx4 v121, s[44:47], s19 offen offset:1024 lds
    s_add_u32 m0, s17, 133120
    s_add_u32 s19, s18, 524288
    buffer_load_dwordx4 v120, s[44:47], s19 offen lds
    buffer_load_dwordx4 v121, s[44:47], s19 offen offset:1024 lds
    s_add_u32 m0, s17, 135168
    s_add_u32 s19, s18, 655360
    buffer_load_dwordx4 v120, s[44:47], s19 offen lds
    buffer_load_dwordx4 v121, s[44:47], s19 offen offset:1024 lds
    s_mov_b32 s66, 0x3fff
    s_branch L_P2_H
L_A_F:
    s_setprio 3
    s_and_b32 s16, s61, 3
    s_lshl_b32 s16, s16, 5
    s_lshr_b32 s18, s2, 3
    s_add_u32 s16, s16, s18
    s_lshr_b32 s18, s61, 2
    s_lshl_b32 s17, s18, 8
    s_add_u32 s17, s17, s16
    s_lshl_b32 s16, s16, 1
    s_add_u32 s16, s16, s18
    v_and_b32 v125, 15, v106
    v_lshrrev_b32 v126, 4, v106
    v_and_b32 v122, 31, v106
    v_lshlrev_b32 v122, 7, v122
    s_mov_b32 s12, 0x30000
    v_lshlrev_b32 v120, 7, v125
    v_lshl_add_u32 v120, v126, 4, v120
    s_lshr_b32 s18, s58, 1
    s_lshl_b32 s18, s18, 7
    s_add_u32 s17, s17, s18
    s_mul_i32 s17, s17, 4224
    s_and_b32 s18, s58, 1
    s_lshl_b32 s18, s18, 11
    s_add_u32 s17, s17, s18
    s_add_u32 s17, s17, 0xe00000
    v_mul_u32_u24 v121, 34816, v125
    v_lshl_add_u32 v121, v126, 4, v121
    v_and_b32 v118, 7, v106
    v_lshl_add_u32 v121, v118, 6, v121
    s_mul_i32 s19, s58, 557056
    s_add_u32 s19, s19, 0x200000
    s_lshl_b32 s18, s16, 6
    s_add_u32 s18, s18, s19
    s_add_u32 s68, s18, 17408
    v_and_b32 v0, 15, v106
    v_lshrrev_b32 v1, 4, v106
    s_lshl_b32 s15, s58, 4
    v_add_u32 v2, s15, v0
    v_cvt_f32_u32 v2, v2
    v_mul_f32 v3, 0x3c800000, v2
    v_lshrrev_b32 v4, 1, v1
    v_lshlrev_b32 v4, 4, v4
    v_and_b32 v5, 1, v1
    v_lshl_add_u32 v4, v5, 2, v4
    v_cvt_f32_u32 v4, v4
    v_mul_f32 v4, v4, v3
    v_mov_b32 v16, v4
    v_fmamk_f32 v17, v3, 0x3f800000, v4
    v_fmamk_f32 v18, v3, 0x40000000, v4
    v_fmamk_f32 v19, v3, 0x40400000, v4
    v_fmamk_f32 v20, v3, 0x41000000, v4
    v_fmamk_f32 v21, v3, 0x41100000, v4
    v_fmamk_f32 v22, v3, 0x41200000, v4
    v_fmamk_f32 v23, v3, 0x41300000, v4
    v_cos_f32 v8, v16
    v_sin_f32 v16, v16
    v_cos_f32 v9, v17
    v_sin_f32 v17, v17
    v_cos_f32 v10, v18
    v_sin_f32 v18, v18
    v_cos_f32 v11, v19
    v_sin_f32 v19, v19
    v_cos_f32 v12, v20
    v_sin_f32 v20, v20
    v_cos_f32 v13, v21
    v_sin_f32 v21, v21
    v_cos_f32 v14, v22
    v_sin_f32 v22, v22
    v_cos_f32 v15, v23
    v_sin_f32 v23, v23
    v_cvt_pk_bf16_f32 v144, v8, v9
    v_cvt_pk_bf16_f32 v148, v16, v17
    v_cvt_pk_bf16_f32 v145, v10, v11
    v_cvt_pk_bf16_f32 v149, v18, v19
    v_cvt_pk_bf16_f32 v146, v12, v13
    v_cvt_pk_bf16_f32 v150, v20, v21
    v_cvt_pk_bf16_f32 v147, v14, v15
    v_cvt_pk_bf16_f32 v151, v22, v23
    v_xor_b32 v152, 0x80008000, v148
    v_xor_b32 v153, 0x80008000, v149
    v_xor_b32 v154, 0x80008000, v150
    v_xor_b32 v155, 0x80008000, v151
    v_fmamk_f32 v16, v3, 0x42000000, v4
    v_fmamk_f32 v17, v3, 0x42040000, v4
    v_fmamk_f32 v18, v3, 0x42080000, v4
    v_fmamk_f32 v19, v3, 0x420c0000, v4
    v_fmamk_f32 v20, v3, 0x42200000, v4
    v_fmamk_f32 v21, v3, 0x42240000, v4
    v_fmamk_f32 v22, v3, 0x42280000, v4
    v_fmamk_f32 v23, v3, 0x422c0000, v4
    v_cos_f32 v8, v16
    v_sin_f32 v16, v16
    v_cos_f32 v9, v17
    v_sin_f32 v17, v17
    v_cos_f32 v10, v18
    v_sin_f32 v18, v18
    v_cos_f32 v11, v19
    v_sin_f32 v19, v19
    v_cos_f32 v12, v20
    v_sin_f32 v20, v20
    v_cos_f32 v13, v21
    v_sin_f32 v21, v21
    v_cos_f32 v14, v22
    v_sin_f32 v22, v22
    v_cos_f32 v15, v23
    v_sin_f32 v23, v23
    v_cvt_pk_bf16_f32 v156, v8, v9
    v_cvt_pk_bf16_f32 v160, v16, v17
    v_cvt_pk_bf16_f32 v157, v10, v11
    v_cvt_pk_bf16_f32 v161, v18, v19
    v_cvt_pk_bf16_f32 v158, v12, v13
    v_cvt_pk_bf16_f32 v162, v20, v21
    v_cvt_pk_bf16_f32 v159, v14, v15
    v_cvt_pk_bf16_f32 v163, v22, v23
    v_xor_b32 v164, 0x80008000, v160
    v_xor_b32 v165, 0x80008000, v161
    v_xor_b32 v166, 0x80008000, v162
    v_xor_b32 v167, 0x80008000, v163
    v_lshlrev_b32 v1, 2, v1
    v_cvt_f32_u32 v1, v1
    v_cvt_f32_u32 v0, v0
    v_mov_b32 v5, v0
    v_mul_f32 v3, 0x3d000000, v5
    v_mul_f32 v4, v1, v3
    v_mov_b32 v16, v4
    v_fmamk_f32 v17, v3, 0x3f800000, v4
    v_fmamk_f32 v18, v3, 0x40000000, v4
    v_fmamk_f32 v19, v3, 0x40400000, v4
    v_fmamk_f32 v20, v3, 0x41800000, v4
    v_fmamk_f32 v21, v3, 0x41880000, v4
    v_fmamk_f32 v22, v3, 0x41900000, v4
    v_fmamk_f32 v23, v3, 0x41980000, v4
    v_cos_f32 v8, v16
    v_sin_f32 v16, v16
    v_cos_f32 v9, v17
    v_sin_f32 v17, v17
    v_cos_f32 v10, v18
    v_sin_f32 v18, v18
    v_cos_f32 v11, v19
    v_sin_f32 v19, v19
    v_cos_f32 v12, v20
    v_sin_f32 v20, v20
    v_cos_f32 v13, v21
    v_sin_f32 v21, v21
    v_cos_f32 v14, v22
    v_sin_f32 v22, v22
    v_cos_f32 v15, v23
    v_sin_f32 v23, v23
    v_cvt_pk_bf16_f32 v168, v8, v9
    v_cvt_pk_bf16_f32 v172, v16, v17
    v_cvt_pk_bf16_f32 v169, v10, v11
    v_cvt_pk_bf16_f32 v173, v18, v19
    v_cvt_pk_bf16_f32 v170, v12, v13
    v_cvt_pk_bf16_f32 v174, v20, v21
    v_cvt_pk_bf16_f32 v171, v14, v15
    v_cvt_pk_bf16_f32 v175, v22, v23
    v_xor_b32 v176, 0x80008000, v172
    v_xor_b32 v177, 0x80008000, v173
    v_xor_b32 v178, 0x80008000, v174
    v_xor_b32 v179, 0x80008000, v175
    v_add_f32 v5, 0x41800000, v0
    v_mul_f32 v3, 0x3d000000, v5
    v_mul_f32 v4, v1, v3
    v_mov_b32 v16, v4
    v_fmamk_f32 v17, v3, 0x3f800000, v4
    v_fmamk_f32 v18, v3, 0x40000000, v4
    v_fmamk_f32 v19, v3, 0x40400000, v4
    v_fmamk_f32 v20, v3, 0x41800000, v4
    v_fmamk_f32 v21, v3, 0x41880000, v4
    v_fmamk_f32 v22, v3, 0x41900000, v4
    v_fmamk_f32 v23, v3, 0x41980000, v4
    v_cos_f32 v8, v16
    v_sin_f32 v16, v16
    v_cos_f32 v9, v17
    v_sin_f32 v17, v17
    v_cos_f32 v10, v18
    v_sin_f32 v18, v18
    v_cos_f32 v11, v19
    v_sin_f32 v19, v19
    v_cos_f32 v12, v20
    v_sin_f32 v20, v20
    v_cos_f32 v13, v21
    v_sin_f32 v21, v21
    v_cos_f32 v14, v22
    v_sin_f32 v22, v22
    v_cos_f32 v15, v23
    v_sin_f32 v23, v23
    v_cvt_pk_bf16_f32 v180, v8, v9
    v_cvt_pk_bf16_f32 v184, v16, v17
    v_cvt_pk_bf16_f32 v181, v10, v11
    v_cvt_pk_bf16_f32 v185, v18, v19
    v_cvt_pk_bf16_f32 v182, v12, v13
    v_cvt_pk_bf16_f32 v186, v20, v21
    v_cvt_pk_bf16_f32 v183, v14, v15
    v_cvt_pk_bf16_f32 v187, v22, v23
    v_xor_b32 v188, 0x80008000, v184
    v_xor_b32 v189, 0x80008000, v185
    v_xor_b32 v190, 0x80008000, v186
    v_xor_b32 v191, 0x80008000, v187
    v_mul_f32 v3, 0x3a000000, v2
    v_mul_f32 v4, v1, v3
    v_mov_b32 v16, v4
    v_fmamk_f32 v17, v3, 0x3f800000, v4
    v_fmamk_f32 v18, v3, 0x40000000, v4
    v_fmamk_f32 v19, v3, 0x40400000, v4
    v_fmamk_f32 v20, v3, 0x41800000, v4
    v_fmamk_f32 v21, v3, 0x41880000, v4
    v_fmamk_f32 v22, v3, 0x41900000, v4
    v_fmamk_f32 v23, v3, 0x41980000, v4
    v_cos_f32 v192, v16
    v_sin_f32 v200, v16
    v_cos_f32 v193, v17
    v_sin_f32 v201, v17
    v_cos_f32 v194, v18
    v_sin_f32 v202, v18
    v_cos_f32 v195, v19
    v_sin_f32 v203, v19
    v_cos_f32 v196, v20
    v_sin_f32 v204, v20
    v_cos_f32 v197, v21
    v_sin_f32 v205, v21
    v_cos_f32 v198, v22
    v_sin_f32 v206, v22
    v_cos_f32 v199, v23
    v_sin_f32 v207, v23
    v_cvt_f32_u32 v2, s15
    v_add_f32 v2, v2, v1
    v_mov_b32 v5, v0
    v_mul_f32 v3, 0x3a000000, v5
    v_mul_f32 v4, v2, v3
    v_mov_b32 v16, v4
    v_fmamk_f32 v17, v3, 0x3f800000, v4
    v_fmamk_f32 v18, v3, 0x40000000, v4
    v_fmamk_f32 v19, v3, 0x40400000, v4
    v_cos_f32 v208, v16
    v_sin_f32 v216, v16
    v_cos_f32 v209, v17
    v_sin_f32 v217, v17
    v_cos_f32 v210, v18
    v_sin_f32 v218, v18
    v_cos_f32 v211, v19
    v_sin_f32 v219, v19
    v_add_f32 v5, 0x41800000, v0
    v_mul_f32 v3, 0x3a000000, v5
    v_mul_f32 v4, v2, v3
    v_mov_b32 v16, v4
    v_fmamk_f32 v17, v3, 0x3f800000, v4
    v_fmamk_f32 v18, v3, 0x40000000, v4
    v_fmamk_f32 v19, v3, 0x40400000, v4
    v_cos_f32 v212, v16
    v_sin_f32 v220, v16
    v_cos_f32 v213, v17
    v_sin_f32 v221, v17
    v_cos_f32 v214, v18
    v_sin_f32 v222, v18
    v_cos_f32 v215, v19
    v_sin_f32 v223, v19
    s_mov_b32 s67, 0
    s_branch L_P2_F
L_P2_H:
    s_setprio 0
    s_mov_b32 s67, 0
    v_mov_b32 v104, 162816
    v_mov_b32 v105, 1
    v_mov_b32 v118, 0
    v_mov_b32 v119, s56
    s_cmp_eq_u32 s66, 0
    s_cbranch_scc1 L_H_FAST
    s_waitcnt vmcnt(0)
    s_cmp_lg_u32 s67, 0
    s_cbranch_scc1 L_HC_1
    s_mov_b32 s67, 1
    s_mov_b64 exec, 1
    buffer_store_dword v119, v118, s[36:39], s5 offen sc1
    s_mov_b64 exec, -1
L_HC_1:
    s_and_b32 s7, s66, 0x3fff
    s_cbranch_scc0 L_HG0_OK
    s_mov_b32 s6, 0
L_HG0:
    s_mov_b32 exec_lo, s66
    s_mov_b32 exec_hi, 0
    buffer_load_dword v127, v126, s[36:39], s9 offen sc1
    s_add_u32 s6, s6, 1
    s_waitcnt vmcnt(0)
    v_cmp_ne_u32 vcc, s56, v127
    s_mov_b64 exec, -1
    s_mov_b32 s66, vcc_lo
    s_cmp_gt_u32 s6, 0x8000
    s_cbranch_scc1 L_HG0_OK
    s_and_b32 s7, s66, 0x3fff
    s_cbranch_scc0 L_HG0_OK
    s_sleep 6
    s_branch L_HG0
L_HG0_OK:
    s_add_u32 s7, s10, 0
    buffer_load_dwordx4 v[168:171], v107, s[36:39], s7 offen sc1
    s_add_u32 s7, s11, 0
    buffer_load_dwordx4 v[172:175], v107, s[36:39], s7 offen sc1
    s_add_u32 s7, s10, 8192
    buffer_load_dwordx4 v[176:179], v107, s[36:39], s7 offen sc1
    s_add_u32 s7, s11, 8192
    buffer_load_dwordx4 v[180:183], v107, s[36:39], s7 offen sc1
    s_add_u32 s7, s10, 16384
    buffer_load_dwordx4 v[184:187], v107, s[36:39], s7 offen sc1
    s_add_u32 s7, s11, 16384
    buffer_load_dwordx4 v[188:191], v107, s[36:39], s7 offen sc1
    s_add_u32 s7, s10, 24576
    buffer_load_dwordx4 v[192:195], v107, s[36:39], s7 offen sc1
    s_add_u32 s7, s11, 24576
    buffer_load_dwordx4 v[196:199], v107, s[36:39], s7 offen sc1
    s_add_u32 s7, s10, 32768
    buffer_load_dwordx4 v[200:203], v107, s[36:39], s7 offen sc1
    s_add_u32 s7, s11, 32768
    buffer_load_dwordx4 v[204:207], v107, s[36:39], s7 offen sc1
    s_add_u32 s7, s10, 40960
    buffer_load_dwordx4 v[208:211], v107, s[36:39], s7 offen sc1
    s_add_u32 s7, s11, 40960
    buffer_load_dwordx4 v[212:215], v107, s[36:39], s7 offen sc1
    s_waitcnt vmcnt(0)
L_H_FAST:
    s_waitcnt vmcnt(12)
    ds_read_b64_tr_b16 v[64:65], v124 offset:0
    ds_read_b64_tr_b16 v[66:67], v124 offset:1024
    ds_read_b64_tr_b16 v[68:69], v125 offset:0
    ds_read_b64_tr_b16 v[70:71], v125 offset:1024
    s_waitcnt lgkmcnt(0)
    v_mfma_f32_32x32x16_bf16 v[0:15], v[64:67], v[168:171], v[0:15]
    ds_read_b64_tr_b16 v[72:73], v124 offset:2048
    ds_read_b64_tr_b16 v[74:75], v124 offset:3072
    v_mfma_f32_32x32x16_bf16 v[16:31], v[64:67], v[172:175], 0
    ds_read_b64_tr_b16 v[76:77], v125 offset:2048
    ds_read_b64_tr_b16 v[78:79], v125 offset:3072
    s_getreg_b32 s7, hwreg(HW_REG_IB_STS)
    s_and_b32 s7, s7, 0xc0000f
    s_or_b32 s7, s7, s67
    s_cbranch_scc1 L_HC_2
    s_mov_b32 s67, 1
    s_mov_b64 exec, 1
    buffer_store_dword v119, v118, s[36:39], s5 offen sc1
    s_mov_b64 exec, -1
L_HC_2:
    v_mfma_f32_32x32x16_bf16 v[32:47], v[68:71], v[168:171], 0
    v_mfma_f32_32x32x16_bf16 v[48:63], v[68:71], v[172:175], 0
    s_waitcnt vmcnt(10) lgkmcnt(0)
    v_mfma_f32_32x32x16_bf16 v[0:15], v[72:75], v[176:179], v[0:15]
    ds_read_b64_tr_b16 v[64:65], v124 offset:4096
    ds_read_b64_tr_b16 v[66:67], v124 offset:5120
    v_mfma_f32_32x32x16_bf16 v[16:31], v[72:75], v[180:183], v[16:31]
    ds_read_b64_tr_b16 v[68:69], v125 offset:4096
    ds_read_b64_tr_b16 v[70:71], v125 offset:5120
    s_getreg_b32 s7, hwreg(HW_REG_IB_STS)
    s_and_b32 s7, s7, 0xc0000f
    s_or_b32 s7, s7, s67
    s_cbranch_scc1 L_HC_3
    s_mov_b32 s67, 1
    s_mov_b64 exec, 1
    buffer_store_dword v119, v118, s[36:39], s5 offen sc1
    s_mov_b64 exec, -1
L_HC_3:
    v_mfma_f32_32x32x16_bf16 v[32:47], v[76:79], v[176:179], v[32:47]
    v_mfma_f32_32x32x16_bf16 v[48:63], v[76:79], v[180:183], v[48:63]
    s_waitcnt vmcnt(8) lgkmcnt(0)
    s_waitcnt vmcnt(0)
    s_cmp_lg_u32 s67, 0
    s_cbranch_scc1 L_HC_4
    s_mov_b32 s67, 1
    s_mov_b64 exec, 1
    buffer_store_dword v119, v118, s[36:39], s5 offen sc1
    s_mov_b64 exec, -1
L_HC_4:
    s_mov_b32 s66, 0xfffffff
    v_mfma_f32_32x32x16_bf16 v[0:15], v[64:67], v[184:187], v[0:15]
    ds_read_b64_tr_b16 v[72:73], v124 offset:32768
    ds_read_b64_tr_b16 v[74:75], v124 offset:33792
    v_mfma_f32_32x32x16_bf16 v[16:31], v[64:67], v[188:191], v[16:31]
    ds_read_b64_tr_b16 v[76:77], v125 offset:32768
    ds_read_b64_tr_b16 v[78:79], v125 offset:33792
    s_add_u32 s7, s10, 49152
    buffer_load_dwordx4 v[216:219], v107, s[36:39], s7 offen sc1
    s_add_u32 s7, s11, 49152
    buffer_load_dwordx4 v[220:223], v107, s[36:39], s7 offen sc1
    v_mfma_f32_32x32x16_bf16 v[32:47], v[68:71], v[184:187], v[32:47]
    s_add_u32 s7, s10, 57344
    buffer_load_dwordx4 v[224:227], v107, s[36:39], s7 offen sc1
    v_mfma_f32_32x32x16_bf16 v[48:63], v[68:71], v[188:191], v[48:63]
    s_add_u32 s7, s11, 57344
    buffer_load_dwordx4 v[228:231], v107, s[36:39], s7 offen sc1
    s_waitcnt lgkmcnt(0)
    v_mfma_f32_32x32x16_bf16 v[0:15], v[72:75], v[192:195], v[0:15]
    ds_read_b64_tr_b16 v[64:65], v124 offset:34816
    ds_read_b64_tr_b16 v[66:67], v124 offset:35840
    v_mfma_f32_32x32x16_bf16 v[16:31], v[72:75], v[196:199], v[16:31]
    ds_read_b64_tr_b16 v[68:69], v125 offset:34816
    ds_read_b64_tr_b16 v[70:71], v125 offset:35840
    s_add_u32 s7, s10, 65536
    buffer_load_dwordx4 v[232:235], v107, s[36:39], s7 offen sc1
    s_add_u32 s7, s11, 65536
    buffer_load_dwordx4 v[236:239], v107, s[36:39], s7 offen sc1
    v_mfma_f32_32x32x16_bf16 v[32:47], v[76:79], v[192:195], v[32:47]
    s_add_u32 m0, s17, 131072
    s_add_u32 s19, s18, 458752
    buffer_load_dwordx4 v120, s[44:47], s19 offen lds
    buffer_load_dwordx4 v121, s[44:47], s19 offen offset:1024 lds
    v_mfma_f32_32x32x16_bf16 v[48:63], v[76:79], v[196:199], v[48:63]
    s_waitcnt lgkmcnt(0)
    v_mfma_f32_32x32x16_bf16 v[0:15], v[64:67], v[200:203], v[0:15]
    ds_read_b64_tr_b16 v[72:73], v124 offset:36864
    ds_read_b64_tr_b16 v[74:75], v124 offset:37888
    v_mfma_f32_32x32x16_bf16 v[16:31], v[64:67], v[204:207], v[16:31]
    ds_read_b64_tr_b16 v[76:77], v125 offset:36864
    ds_read_b64_tr_b16 v[78:79], v125 offset:37888
    s_add_u32 s7, s10, 73728
    buffer_load_dwordx4 v[240:243], v107, s[36:39], s7 offen sc1
    s_add_u32 s7, s11, 73728
    buffer_load_dwordx4 v[244:247], v107, s[36:39], s7 offen sc1
    v_mfma_f32_32x32x16_bf16 v[32:47], v[68:71], v[200:203], v[32:47]
    s_add_u32 m0, s17, 133120
    s_add_u32 s19, s18, 589824
    buffer_load_dwordx4 v120, s[44:47], s19 offen lds
    buffer_load_dwordx4 v121, s[44:47], s19 offen offset:1024 lds
    v_mfma_f32_32x32x16_bf16 v[48:63], v[68:71], v[204:207], v[48:63]
    s_waitcnt lgkmcnt(0)
    v_mfma_f32_32x32x16_bf16 v[0:15], v[72:75], v[208:211], v[0:15]
    ds_read_b64_tr_b16 v[64:65], v122 offset:0
    ds_read_b64_tr_b16 v[66:67], v122 offset:1024
    v_mfma_f32_32x32x16_bf16 v[16:31], v[72:75], v[212:215], v[16:31]
    ds_read_b64_tr_b16 v[68:69], v123 offset:0
    ds_read_b64_tr_b16 v[70:71], v123 offset:1024
    s_add_u32 s7, s10, 81920
    buffer_load_dwordx4 v[248:251], v107, s[36:39], s7 offen sc1
    s_add_u32 s7, s11, 81920
    buffer_load_dwordx4 v[252:255], v107, s[36:39], s7 offen sc1
    v_mfma_f32_32x32x16_bf16 v[32:47], v[76:79], v[208:211], v[32:47]
    s_add_u32 m0, s17, 135168
    s_add_u32 s19, s18, 720896
    buffer_load_dwordx4 v120, s[44:47], s19 offen lds
    buffer_load_dwordx4 v121, s[44:47], s19 offen offset:1024 lds
    v_mfma_f32_32x32x16_bf16 v[48:63], v[76:79], v[212:215], v[48:63]
    s_waitcnt vmcnt(14) lgkmcnt(0)
    v_mfma_f32_32x32x16_bf16 v[0:15], v[64:67], v[216:219], v[0:15]
    ds_read_b64_tr_b16 v[72:73], v122 offset:2048
    ds_read_b64_tr_b16 v[74:75], v122 offset:3072
    v_mfma_f32_32x32x16_bf16 v[16:31], v[64:67], v[220:223], v[16:31]
    ds_read_b64_tr_b16 v[76:77], v123 offset:2048
    ds_read_b64_tr_b16 v[78:79], v123 offset:3072
    s_add_u32 s7, s10, 90112
    buffer_load_dwordx4 v[128:131], v107, s[36:39], s7 offen sc1
    s_add_u32 s7, s11, 90112
    buffer_load_dwordx4 v[132:135], v107, s[36:39], s7 offen sc1
    v_mfma_f32_32x32x16_bf16 v[32:47], v[68:71], v[216:219], v[32:47]
    s_add_u32 m0, s17, 32768
    s_add_u32 s19, s18, 851968
    buffer_load_dwordx4 v120, s[44:47], s19 offen lds
    buffer_load_dwordx4 v121, s[44:47], s19 offen offset:1024 lds
    v_mfma_f32_32x32x16_bf16 v[48:63], v[68:71], v[220:223], v[48:63]
    s_waitcnt vmcnt(16) lgkmcnt(0)
    v_mfma_f32_32x32x16_bf16 v[0:15], v[72:75], v[224:227], v[0:15]
    ds_read_b64_tr_b16 v[64:65], v122 offset:4096
    ds_read_b64_tr_b16 v[66:67], v122 offset:5120
    v_mfma_f32_32x32x16_bf16 v[16:31], v[72:75], v[228:231], v[16:31]
    ds_read_b64_tr_b16 v[68:69], v123 offset:4096
    ds_read_b64_tr_b16 v[70:71], v123 offset:5120
    s_add_u32 s7, s10, 98304
    buffer_load_dwordx4 v[136:139], v107, s[36:39], s7 offen sc1
    s_add_u32 s7, s11, 98304
    buffer_load_dwordx4 v[140:143], v107, s[36:39], s7 offen sc1
    v_mfma_f32_32x32x16_bf16 v[32:47], v[76:79], v[224:227], v[32:47]
    s_add_u32 m0, s17, 34816
    s_add_u32 s19, s18, 983040
    buffer_load_dwordx4 v120, s[44:47], s19 offen lds
    buffer_load_dwordx4 v121, s[44:47], s19 offen offset:1024 lds
    v_mfma_f32_32x32x16_bf16 v[48:63], v[76:79], v[228:231], v[48:63]
    s_waitcnt vmcnt(18) lgkmcnt(0)
    v_mfma_f32_32x32x16_bf16 v[0:15], v[64:67], v[232:235], v[0:15]
    ds_read_b64_tr_b16 v[72:73], v122 offset:6144
    ds_read_b64_tr_b16 v[74:75], v122 offset:7168
    v_mfma_f32_32x32x16_bf16 v[16:31], v[64:67], v[236:239], v[16:31]
    ds_read_b64_tr_b16 v[76:77], v123 offset:6144
    ds_read_b64_tr_b16 v[78:79], v123 offset:7168
    s_add_u32 s7, s10, 106496
    buffer_load_dwordx4 v[168:171], v107, s[36:39], s7 offen sc1
    s_add_u32 s7, s11, 106496
    buffer_load_dwordx4 v[172:175], v107, s[36:39], s7 offen sc1
    v_mfma_f32_32x32x16_bf16 v[32:47], v[68:71], v[232:235], v[32:47]
    s_add_u32 m0, s17, 36864
    s_add_u32 s19, s18, 1114112
    buffer_load_dwordx4 v120, s[44:47], s19 offen lds
    buffer_load_dwordx4 v121, s[44:47], s19 offen offset:1024 lds
    v_mfma_f32_32x32x16_bf16 v[48:63], v[68:71], v[236:239], v[48:63]
    s_waitcnt vmcnt(18) lgkmcnt(0)
    v_mfma_f32_32x32x16_bf16 v[0:15], v[72:75], v[240:243], v[0:15]
    ds_read_b64_tr_b16 v[64:65], v122 offset:32768
    ds_read_b64_tr_b16 v[66:67], v122 offset:33792
    v_mfma_f32_32x32x16_bf16 v[16:31], v[72:75], v[244:247], v[16:31]
    ds_read_b64_tr_b16 v[68:69], v123 offset:32768
    ds_read_b64_tr_b16 v[70:71], v123 offset:33792
    s_and_b32 s7, s66, 0x3fff
    s_cbranch_scc0 L_HG1_0_OK
    s_mov_b32 s6, 0
L_HG1_0:
    s_mov_b32 exec_lo, s66
    s_mov_b32 exec_hi, 0
    buffer_load_dword v127, v126, s[36:39], s16 offen sc1
    s_add_u32 s6, s6, 1
    s_waitcnt vmcnt(0)
    v_cmp_ne_u32 vcc, s56, v127
    s_mov_b64 exec, -1
    s_mov_b32 s66, vcc_lo
    s_cmp_gt_u32 s6, 0x8000
    s_cbranch_scc1 L_HG1_0_OK
    s_and_b32 s7, s66, 0x3fff
    s_cbranch_scc0 L_HG1_0_OK
    s_sleep 6
    s_branch L_HG1_0
L_HG1_0_OK:
    s_add_u32 s7, s10, 4096
    buffer_load_dwordx4 v[176:179], v107, s[36:39], s7 offen sc1
    v_mfma_f32_32x32x16_bf16 v[32:47], v[76:79], v[240:243], v[32:47]
    v_mfma_f32_32x32x16_bf16 v[48:63], v[76:79], v[244:247], v[48:63]
    s_add_u32 s7, s11, 4096
    buffer_load_dwordx4 v[180:183], v107, s[36:39], s7 offen sc1
    s_add_u32 m0, s17, 38912
    s_add_u32 s19, s18, 1245184
    buffer_load_dwordx4 v120, s[44:47], s19 offen lds
    buffer_load_dwordx4 v121, s[44:47], s19 offen offset:1024 lds
    s_waitcnt vmcnt(18) lgkmcnt(0)
    v_mfma_f32_32x32x16_bf16 v[0:15], v[64:67], v[248:251], v[0:15]
    ds_read_b64_tr_b16 v[72:73], v122 offset:34816
    ds_read_b64_tr_b16 v[74:75], v122 offset:35840
    v_mfma_f32_32x32x16_bf16 v[16:31], v[64:67], v[252:255], v[16:31]
    ds_read_b64_tr_b16 v[76:77], v123 offset:34816
    ds_read_b64_tr_b16 v[78:79], v123 offset:35840
    s_add_u32 s7, s10, 12288
    buffer_load_dwordx4 v[184:187], v107, s[36:39], s7 offen sc1
    s_add_u32 s7, s11, 12288
    buffer_load_dwordx4 v[188:191], v107, s[36:39], s7 offen sc1
    v_mfma_f32_32x32x16_bf16 v[32:47], v[68:71], v[248:251], v[32:47]
    s_add_u32 m0, s17, 65536
    s_add_u32 s19, s18, 1376256
    buffer_load_dwordx4 v120, s[44:47], s19 offen lds
    buffer_load_dwordx4 v121, s[44:47], s19 offen offset:1024 lds
    v_mfma_f32_32x32x16_bf16 v[48:63], v[68:71], v[252:255], v[48:63]
    s_waitcnt vmcnt(18) lgkmcnt(0)
    v_mfma_f32_32x32x16_bf16 v[0:15], v[72:75], v[128:131], v[0:15]
    ds_read_b64_tr_b16 v[64:65], v122 offset:36864
    ds_read_b64_tr_b16 v[66:67], v122 offset:37888
    v_mfma_f32_32x32x16_bf16 v[16:31], v[72:75], v[132:135], v[16:31]
    ds_read_b64_tr_b16 v[68:69], v123 offset:36864
    ds_read_b64_tr_b16 v[70:71], v123 offset:37888
    s_add_u32 s7, s10, 20480
    buffer_load_dwordx4 v[192:195], v107, s[36:39], s7 offen sc1
    s_add_u32 s7, s11, 20480
    buffer_load_dwordx4 v[196:199], v107, s[36:39], s7 offen sc1
    v_mfma_f32_32x32x16_bf16 v[32:47], v[76:79], v[128:131], v[32:47]
    s_add_u32 m0, s17, 67584
    s_add_u32 s19, s18, 1507328
    buffer_load_dwordx4 v120, s[44:47], s19 offen lds
    buffer_load_dwordx4 v121, s[44:47], s19 offen offset:1024 lds
    v_mfma_f32_32x32x16_bf16 v[48:63], v[76:79], v[132:135], v[48:63]
    s_waitcnt vmcnt(18) lgkmcnt(0)
    v_mfma_f32_32x32x16_bf16 v[0:15], v[64:67], v[136:139], v[0:15]
    ds_read_b64_tr_b16 v[72:73], v122 offset:38912
    ds_read_b64_tr_b16 v[74:75], v122 offset:39936
    v_mfma_f32_32x32x16_bf16 v[16:31], v[64:67], v[140:143], v[16:31]
    ds_read_b64_tr_b16 v[76:77], v123 offset:38912
    ds_read_b64_tr_b16 v[78:79], v123 offset:39936
    s_add_u32 s7, s10, 28672
    buffer_load_dwordx4 v[200:203], v107, s[36:39], s7 offen sc1
    s_add_u32 s7, s11, 28672
    buffer_load_dwordx4 v[204:207], v107, s[36:39], s7 offen sc1
    v_mfma_f32_32x32x16_bf16 v[32:47], v[68:71], v[136:139], v[32:47]
    s_add_u32 m0, s17, 69632
    s_add_u32 s19, s18, 1638400
    buffer_load_dwordx4 v120, s[44:47], s19 offen lds
    buffer_load_dwordx4 v121, s[44:47], s19 offen offset:1024 lds
    v_mfma_f32_32x32x16_bf16 v[48:63], v[68:71], v[140:143], v[48:63]
    s_waitcnt vmcnt(18) lgkmcnt(0)
    v_mfma_f32_32x32x16_bf16 v[0:15], v[72:75], v[168:171], v[0:15]
    v_mfma_f32_32x32x16_bf16 v[16:31], v[72:75], v[172:175], v[16:31]
    s_add_u32 s7, s10, 36864
    buffer_load_dwordx4 v[208:211], v107, s[36:39], s7 offen sc1
    s_add_u32 s7, s11, 36864
    buffer_load_dwordx4 v[212:215], v107, s[36:39], s7 offen sc1
    v_mfma_f32_32x32x16_bf16 v[32:47], v[76:79], v[168:171], v[32:47]
    s_add_u32 m0, s17, 71680
    s_add_u32 s19, s18, 1769472
    buffer_load_dwordx4 v120, s[44:47], s19 offen lds
    buffer_load_dwordx4 v121, s[44:47], s19 offen offset:1024 lds
    v_mfma_f32_32x32x16_bf16 v[48:63], v[76:79], v[172:175], v[48:63]
    s_waitcnt vmcnt(18) lgkmcnt(0)
    v_mfma_f32_32x32x16_bf16 v[0:15], v[144:147], v[176:179], v[0:15]
    v_mfma_f32_32x32x16_bf16 v[16:31], v[144:147], v[180:183], v[16:31]
    s_add_u32 s7, s10, 45056
    buffer_load_dwordx4 v[216:219], v107, s[36:39], s7 offen sc1
    v_mfma_f32_32x32x16_bf16 v[32:47], v[148:151], v[176:179], v[32:47]
    s_add_u32 s7, s11, 45056
    buffer_load_dwordx4 v[220:223], v107, s[36:39], s7 offen sc1
    v_mfma_f32_32x32x16_bf16 v[48:63], v[148:151], v[180:183], v[48:63]
    s_waitcnt vmcnt(16) lgkmcnt(0)
    v_mfma_f32_32x32x16_bf16 v[0:15], v[152:155], v[184:187], v[0:15]
    v_mfma_f32_32x32x16_bf16 v[16:31], v[152:155], v[188:191], v[16:31]
    s_add_u32 s7, s10, 53248
    buffer_load_dwordx4 v[224:227], v107, s[36:39], s7 offen sc1
    v_mfma_f32_32x32x16_bf16 v[32:47], v[156:159], v[184:187], v[32:47]
    s_add_u32 s7, s11, 53248
    buffer_load_dwordx4 v[228:231], v107, s[36:39], s7 offen sc1
    v_mfma_f32_32x32x16_bf16 v[48:63], v[156:159], v[188:191], v[48:63]
    s_waitcnt vmcnt(14) lgkmcnt(0)
    v_mfma_f32_32x32x16_bf16 v[0:15], v[160:163], v[192:195], v[0:15]
    ds_read_b64_tr_b16 v[72:73], v124 offset:32768
    ds_read_b64_tr_b16 v[74:75], v124 offset:33792
    v_mfma_f32_32x32x16_bf16 v[16:31], v[160:163], v[196:199], v[16:31]
    ds_read_b64_tr_b16 v[76:77], v125 offset:32768
    ds_read_b64_tr_b16 v[78:79], v125 offset:33792
    s_and_b32 s7, s66, 0xfffc000
    s_cbranch_scc0 L_HG1_1_OK
    s_mov_b32 s6, 0
L_HG1_1:
    s_mov_b32 exec_lo, s66
    s_mov_b32 exec_hi, 0
    buffer_load_dword v127, v126, s[36:39], s16 offen sc1
    s_add_u32 s6, s6, 1
    s_waitcnt vmcnt(0)
    v_cmp_ne_u32 vcc, s56, v127
    s_mov_b64 exec, -1
    s_mov_b32 s66, vcc_lo
    s_cmp_gt_u32 s6, 0x8000
    s_cbranch_scc1 L_HG1_1_OK
    s_and_b32 s7, s66, 0xfffc000
    s_cbranch_scc0 L_HG1_1_OK
    s_sleep 6
    s_branch L_HG1_1
L_HG1_1_OK:
    s_add_u32 s7, s10, 61440
    buffer_load_dwordx4 v[232:235], v107, s[36:39], s7 offen sc1
    v_mfma_f32_32x32x16_bf16 v[32:47], v[164:167], v[192:195], v[32:47]
    v_mfma_f32_32x32x16_bf16 v[48:63], v[164:167], v[196:199], v[48:63]
    s_add_u32 s7, s11, 61440
    buffer_load_dwordx4 v[236:239], v107, s[36:39], s7 offen sc1
    s_waitcnt vmcnt(12) lgkmcnt(0)
    v_mfma_f32_32x32x16_bf16 v[0:15], v[72:75], v[200:203], v[0:15]
    ds_read_b64_tr_b16 v[64:65], v124 offset:34816
    ds_read_b64_tr_b16 v[66:67], v124 offset:35840
    v_mfma_f32_32x32x16_bf16 v[16:31], v[72:75], v[204:207], v[16:31]
    ds_read_b64_tr_b16 v[68:69], v125 offset:34816
    ds_read_b64_tr_b16 v[70:71], v125 offset:35840
    s_add_u32 s7, s10, 69632
    buffer_load_dwordx4 v[240:243], v107, s[36:39], s7 offen sc1
    v_mfma_f32_32x32x16_bf16 v[32:47], v[76:79], v[200:203], v[32:47]
    s_add_u32 s7, s11, 69632
    buffer_load_dwordx4 v[244:247], v107, s[36:39], s7 offen sc1
    v_mfma_f32_32x32x16_bf16 v[48:63], v[76:79], v[204:207], v[48:63]
    s_waitcnt vmcnt(10) lgkmcnt(0)
    v_mfma_f32_32x32x16_bf16 v[0:15], v[64:67], v[208:211], v[0:15]
    ds_read_b64_tr_b16 v[72:73], v124 offset:36864
    ds_read_b64_tr_b16 v[74:75], v124 offset:37888
    v_mfma_f32_32x32x16_bf16 v[16:31], v[64:67], v[212:215], v[16:31]
    ds_read_b64_tr_b16 v[76:77], v125 offset:36864
    ds_read_b64_tr_b16 v[78:79], v125 offset:37888
    s_add_u32 s7, s10, 77824
    buffer_load_dwordx4 v[248:251], v107, s[36:39], s7 offen sc1
    v_mfma_f32_32x32x16_bf16 v[32:47], v[68:71], v[208:211], v[32:47]
    s_add_u32 s7, s11, 77824
    buffer_load_dwordx4 v[252:255], v107, s[36:39], s7 offen sc1
    v_mfma_f32_32x32x16_bf16 v[48:63], v[68:71], v[212:215], v[48:63]
    s_waitcnt vmcnt(8) lgkmcnt(0)
    v_mfma_f32_32x32x16_bf16 v[0:15], v[72:75], v[216:219], v[0:15]
    ds_read_b64_tr_b16 v[64:65], v122 offset:0
    ds_read_b64_tr_b16 v[66:67], v122 offset:1024
    v_mfma_f32_32x32x16_bf16 v[16:31], v[72:75], v[220:223], v[16:31]
    ds_read_b64_tr_b16 v[68:69], v123 offset:0
    ds_read_b64_tr_b16 v[70:71], v123 offset:1024
    s_add_u32 s7, s10, 86016
    buffer_load_dwordx4 v[128:131], v107, s[36:39], s7 offen sc1
    v_mfma_f32_32x32x16_bf16 v[32:47], v[76:79], v[216:219], v[32:47]
    s_add_u32 s7, s11, 86016
    buffer_load_dwordx4 v[132:135], v107, s[36:39], s7 offen sc1
    v_mfma_f32_32x32x16_bf16 v[48:63], v[76:79], v[220:223], v[48:63]
    s_waitcnt vmcnt(8) lgkmcnt(0)
    v_mfma_f32_32x32x16_bf16 v[0:15], v[64:67], v[224:227], v[0:15]
    ds_read_b64_tr_b16 v[72:73], v122 offset:2048
    ds_read_b64_tr_b16 v[74:75], v122 offset:3072
    v_mfma_f32_32x32x16_bf16 v[16:31], v[64:67], v[228:231], v[16:31]
    ds_read_b64_tr_b16 v[76:77], v123 offset:2048
    ds_read_b64_tr_b16 v[78:79], v123 offset:3072
    s_add_u32 s7, s10, 94208
    buffer_load_dwordx4 v[136:139], v107, s[36:39], s7 offen sc1
    v_mfma_f32_32x32x16_bf16 v[32:47], v[68:71], v[224:227], v[32:47]
    s_add_u32 s7, s11, 94208
    buffer_load_dwordx4 v[140:143], v107, s[36:39], s7 offen sc1
    v_mfma_f32_32x32x16_bf16 v[48:63], v[68:71], v[228:231], v[48:63]
    s_lshl_b32 s7, s58, 2
    v_add_u32 v116, s7, v104
    s_mov_b64 exec, 1
    ds_add_u32 v116, v105 offset:32
    s_mov_b64 exec, -1
    s_waitcnt vmcnt(8) lgkmcnt(0)
    v_mfma_f32_32x32x16_bf16 v[0:15], v[72:75], v[232:235], v[0:15]
    ds_read_b64_tr_b16 v[64:65], v122 offset:4096
    ds_read_b64_tr_b16 v[66:67], v122 offset:5120
    v_mfma_f32_32x32x16_bf16 v[16:31], v[72:75], v[236:239], v[16:31]
    ds_read_b64_tr_b16 v[68:69], v123 offset:4096
    ds_read_b64_tr_b16 v[70:71], v123 offset:5120
    s_add_u32 s7, s10, 102400
    buffer_load_dwordx4 v[168:171], v107, s[36:39], s7 offen sc1
    v_mfma_f32_32x32x16_bf16 v[32:47], v[76:79], v[232:235], v[32:47]
    s_add_u32 s7, s11, 102400
    buffer_load_dwordx4 v[172:175], v107, s[36:39], s7 offen sc1
    v_mfma_f32_32x32x16_bf16 v[48:63], v[76:79], v[236:239], v[48:63]
    s_waitcnt vmcnt(8) lgkmcnt(0)
    v_mfma_f32_32x32x16_bf16 v[0:15], v[64:67], v[240:243], v[0:15]
    ds_read_b64_tr_b16 v[72:73], v122 offset:6144
    ds_read_b64_tr_b16 v[74:75], v122 offset:7168
    v_mfma_f32_32x32x16_bf16 v[16:31], v[64:67], v[244:247], v[16:31]
    ds_read_b64_tr_b16 v[76:77], v123 offset:6144
    ds_read_b64_tr_b16 v[78:79], v123 offset:7168
    s_add_u32 s7, s10, 110592
    buffer_load_dwordx4 v[176:179], v107, s[36:39], s7 offen sc1
    v_mfma_f32_32x32x16_bf16 v[32:47], v[68:71], v[240:243], v[32:47]
    s_add_u32 s7, s11, 110592
    buffer_load_dwordx4 v[180:183], v107, s[36:39], s7 offen sc1
    v_mfma_f32_32x32x16_bf16 v[48:63], v[68:71], v[244:247], v[48:63]
    s_waitcnt vmcnt(8) lgkmcnt(0)
    v_mfma_f32_32x32x16_bf16 v[0:15], v[72:75], v[248:251], v[0:15]
    ds_read_b64_tr_b16 v[64:65], v122 offset:32768
    ds_read_b64_tr_b16 v[66:67], v122 offset:33792
    v_mfma_f32_32x32x16_bf16 v[16:31], v[72:75], v[252:255], v[16:31]
    ds_read_b64_tr_b16 v[68:69], v123 offset:32768
    ds_read_b64_tr_b16 v[70:71], v123 offset:33792
    s_lshl_b32 s8, s61, 2
    s_and_b32 s9, s62, 3
    s_add_u32 s8, s8, s9
    s_lshl_b32 s14, s8, 16
    s_and_b32 s15, s58, 1
    s_lshl_b32 s15, s15, 15
    s_add_u32 s14, s14, s15
    s_lshr_b32 s15, s62, 2
    s_lshl_b32 s15, s15, 7
    s_add_u32 s14, s14, s15
    s_lshr_b32 s15, s58, 1
    s_lshl_b32 s15, s15, 6
    s_add_u32 s14, s14, s15
    s_lshr_b32 s9, s57, 2
    s_lshl_b32 s15, s9, 5
    s_add_u32 s14, s14, s15
    v_and_b32 v88, 31, v106
    v_lshlrev_b32 v88, 10, v88
    v_lshrrev_b32 v108, 5, v106
    v_lshl_add_u32 v88, v108, 4, v88
    v_mfma_f32_32x32x16_bf16 v[32:47], v[76:79], v[248:251], v[32:47]
    v_mfma_f32_32x32x16_bf16 v[48:63], v[76:79], v[252:255], v[48:63]
    s_waitcnt vmcnt(6) lgkmcnt(0)
    v_mfma_f32_32x32x16_bf16 v[0:15], v[64:67], v[128:131], v[0:15]
    ds_read_b64_tr_b16 v[72:73], v122 offset:34816
    ds_read_b64_tr_b16 v[74:75], v122 offset:35840
    v_mfma_f32_32x32x16_bf16 v[16:31], v[64:67], v[132:135], v[16:31]
    ds_read_b64_tr_b16 v[76:77], v123 offset:34816
    ds_read_b64_tr_b16 v[78:79], v123 offset:35840
    s_lshl_b32 s9, s9, 11
    s_xor_b32 s10, s58, 0
    s_and_b32 s11, s10, 1
    s_lshl_b32 s11, s11, 12
    s_lshr_b32 s10, s10, 1
    s_lshl_b32 s10, s10, 15
    s_add_u32 s10, s10, s11
    s_add_u32 s10, s10, 32768
    s_add_u32 s10, s10, s9
    v_add_u32 v108, s10, v107
    s_xor_b32 s10, s58, 1
    s_and_b32 s11, s10, 1
    s_lshl_b32 s11, s11, 12
    s_lshr_b32 s10, s10, 1
    s_lshl_b32 s10, s10, 15
    s_add_u32 s10, s10, s11
    s_add_u32 s10, s10, 40960
    s_add_u32 s10, s10, s9
    v_add_u32 v109, s10, v107
    s_xor_b32 s10, s58, 2
    v_mfma_f32_32x32x16_bf16 v[32:47], v[68:71], v[128:131], v[32:47]
    v_mfma_f32_32x32x16_bf16 v[48:63], v[68:71], v[132:135], v[48:63]
    v_add_u32 v116, s17, v107
    v_add_u32 v116, 32768, v116
    ds_read_b64_tr_b16 v[64:65], v122 offset:36864
    ds_read_b64_tr_b16 v[66:67], v122 offset:37888
    ds_read_b64_tr_b16 v[68:69], v123 offset:36864
    ds_read_b64_tr_b16 v[70:71], v123 offset:37888
    ds_read_b64_tr_b16 v[80:81], v122 offset:38912
    ds_read_b64_tr_b16 v[82:83], v122 offset:39936
    ds_read_b64_tr_b16 v[84:85], v123 offset:38912
    ds_read_b64_tr_b16 v[86:87], v123 offset:39936
    s_waitcnt vmcnt(4) lgkmcnt(8)
    v_mfma_f32_32x32x16_bf16 v[0:15], v[72:75], v[136:139], v[0:15]
    s_waitcnt vmcnt(2) lgkmcnt(4)
    v_mfma_f32_32x32x16_bf16 v[0:15], v[64:67], v[168:171], v[0:15]
    s_waitcnt vmcnt(0) lgkmcnt(0)
    v_mfma_f32_32x32x16_bf16 v[0:15], v[80:83], v[176:179], v[0:15]
    v_mfma_f32_32x32x16_bf16 v[16:31], v[72:75], v[140:143], v[16:31]
    v_mfma_f32_32x32x16_bf16 v[16:31], v[64:67], v[172:175], v[16:31]
    s_nop 9
    ds_write_b128 v116, v[0:3] offset:0
    ds_write_b128 v116, v[4:7] offset:1024
    v_mfma_f32_32x32x16_bf16 v[16:31], v[80:83], v[180:183], v[16:31]
    ds_write_b128 v116, v[8:11] offset:2048
    ds_write_b128 v116, v[12:15] offset:3072
    v_mfma_f32_32x32x16_bf16 v[32:47], v[76:79], v[136:139], v[32:47]
    v_mfma_f32_32x32x16_bf16 v[32:47], v[68:71], v[168:171], v[32:47]
    s_nop 7
    ds_write_b128 v116, v[16:19] offset:4096
    ds_write_b128 v116, v[20:23] offset:5120
    v_mfma_f32_32x32x16_bf16 v[32:47], v[84:87], v[176:179], v[32:47]
    ds_write_b128 v116, v[24:27] offset:6144
    ds_write_b128 v116, v[28:31] offset:7168
    v_mfma_f32_32x32x16_bf16 v[48:63], v[76:79], v[140:143], v[48:63]
    v_mfma_f32_32x32x16_bf16 v[48:63], v[68:71], v[172:175], v[48:63]
    s_nop 7
    ds_write_b128 v116, v[32:35] offset:32768
    ds_write_b128 v116, v[36:39] offset:33792
    v_mfma_f32_32x32x16_bf16 v[48:63], v[84:87], v[180:183], v[48:63]
    ds_write_b128 v116, v[40:43] offset:34816
    ds_write_b128 v116, v[44:47] offset:35840
    s_nop 9
    ds_write_b128 v116, v[48:51] offset:36864
    ds_write_b128 v116, v[52:55] offset:37888
    ds_write_b128 v116, v[56:59] offset:38912
    ds_write_b128 v116, v[60:63] offset:39936
    s_and_b32 s11, s10, 1
    s_lshl_b32 s11, s11, 12
    s_lshr_b32 s10, s10, 1
    s_lshl_b32 s10, s10, 15
    s_add_u32 s10, s10, s11
    s_add_u32 s10, s10, 49152
    s_add_u32 s10, s10, s9
    v_add_u32 v110, s10, v107
    s_xor_b32 s10, s58, 3
    s_and_b32 s11, s10, 1
    s_lshl_b32 s11, s11, 12
    s_lshr_b32 s10, s10, 1
    s_lshl_b32 s10, s10, 15
    s_add_u32 s10, s10, s11
    s_add_u32 s10, s10, 57344
    s_add_u32 s10, s10, s9
    v_add_u32 v111, s10, v107
    s_and_b32 s10, s58, 1
    s_lshl_b32 s10, s10, 12
    s_lshr_b32 s11, s58, 1
    s_mul_i32 s11, s11, 98304
    s_add_u32 s10, s10, s11
    s_add_u32 s10, s10, s9
    s_add_u32 s11, s10, 0
    v_add_u32 v112, s11, v107
    s_add_u32 s11, s10, 8192
    v_add_u32 v113, s11, v107
    s_add_u32 s11, s10, 16384
    v_add_u32 v114, s11, v107
    s_add_u32 s11, s10, 24576
    v_add_u32 v115, s11, v107
    s_branch L_FINAL
L_P2_F:
    s_mov_b32 s66, 0
    s_cmp_eq_u32 s67, 1
    s_cbranch_scc1 L_WDONE
    v_mov_b32 v124, 1
    v_mov_b32 v127, 162816
    s_waitcnt vmcnt(0)
    v_mov_b32 v116, 0
    v_mov_b32 v117, s56
    s_mov_b64 exec, 1
    buffer_store_dword v117, v116, s[36:39], s5 offen sc1
    s_mov_b64 exec, -1
    buffer_load_dword v123, v122, s[36:39], s12 offen sc1
    s_waitcnt vmcnt(0)
    v_cmp_ne_u32 vcc, s56, v123
    s_cbranch_vccz L_FA_OK
    s_mov_b32 s6, 0
L_FA_RETRY:
    s_sleep 4
    buffer_load_dword v123, v122, s[36:39], s12 offen sc1
    s_add_u32 s6, s6, 1
    s_cmp_gt_u32 s6, 0x8000
    s_waitcnt vmcnt(0)
    s_cbranch_scc1 L_FA_OK
    v_cmp_ne_u32 vcc, s56, v123
    s_cbranch_vccnz L_FA_RETRY
L_FA_OK:
    buffer_load_dwordx4 v[128:131], v120, s[36:39], s17 offen sc1
    buffer_load_dwordx4 v[132:135], v120, s[36:39], s17 offen offset:64 sc1
    buffer_load_dwordx4 v[136:139], v121, s[36:39], s18 offen sc1
    buffer_load_dwordx4 v[140:143], v121, s[36:39], s68 offen sc1
    s_mov_b32 s5, 0x7000000
    s_cmp_eq_u32 s16, 0
    s_cbranch_scc1 L_WSPEC
    s_waitcnt vmcnt(0)
    s_lshl_b32 s11, s58, 13
    s_add_u32 s11, s11, 104448
    v_add_u32 v119, s11, v107
    ds_write_b128 v119, v[128:131]
    ds_write_b128 v119, v[132:135] offset:1024
    s_mov_b64 exec, 1
    ds_add_u32 v127, v124 offset:28
    s_mov_b64 exec, -1
    v_lshlrev_b32 v0, 16, v136
    v_and_b32 v1, 0xffff0000, v136
    v_lshlrev_b32 v2, 16, v137
    v_and_b32 v3, 0xffff0000, v137
    v_lshlrev_b32 v4, 16, v138
    v_and_b32 v5, 0xffff0000, v138
    v_lshlrev_b32 v6, 16, v139
    v_and_b32 v7, 0xffff0000, v139
    v_lshlrev_b32 v8, 16, v140
    v_and_b32 v9, 0xffff0000, v140
    v_lshlrev_b32 v10, 16, v141
    v_and_b32 v11, 0xffff0000, v141
    v_lshlrev_b32 v12, 16, v142
    v_and_b32 v13, 0xffff0000, v142
    v_lshlrev_b32 v14, 16, v143
    v_and_b32 v15, 0xffff0000, v143
    v_mul_f32 v0, 0x36000000, v0
    v_mul_f32 v1, 0x36000000, v1
    v_mul_f32 v2, 0x36000000, v2
    v_mul_f32 v3, 0x36000000, v3
    v_mul_f32 v4, 0x36000000, v4
    v_mul_f32 v5, 0x36000000, v5
    v_mul_f32 v6, 0x36000000, v6
    v_mul_f32 v7, 0x36000000, v7
    v_mul_f32 v8, 0x36000000, v8
    v_mul_f32 v9, 0x36000000, v9
    v_mul_f32 v10, 0x36000000, v10
    v_mul_f32 v11, 0x36000000, v11
    v_mul_f32 v12, 0x36000000, v12
    v_mul_f32 v13, 0x36000000, v13
    v_mul_f32 v14, 0x36000000, v14
    v_mul_f32 v15, 0x36000000, v15
    s_branch L_WDONE
L_WSPEC:
    s_add_u32 s18, s19, 16384
    s_add_u32 s68, s19, 33792
    buffer_load_dwordx4 v[32:35], v121, s[36:39], s18 offen sc1
    buffer_load_dwordx4 v[36:39], v121, s[36:39], s68 offen sc1
    s_lshl_b32 s9, s58, 4
    v_add_u32 v116, s9, v125
    v_lshl_add_u32 v116, v126, 8, v116
    s_mov_b32 s8, 0x200000
    s_mov_b32 s9, 0x204400
    s_mov_b32 s10, 0x204000
    s_mov_b32 s13, 0x208400
    v_sub_u32 v117, 64, v116
    v_and_b32 v118, 63, v117
    v_mul_u32_u24 v118, 34816, v118
    v_and_b32 v119, 7, v117
    v_lshl_add_u32 v118, v119, 6, v118
    v_xor_b32 v119, 3, v126
    v_lshl_add_u32 v118, v119, 4, v118
    buffer_load_dwordx4 v[56:59], v118, s[36:39], s8 offen sc1
    buffer_load_dwordx4 v[60:63], v118, s[36:39], s9 offen sc1
    buffer_load_dwordx4 v[64:67], v118, s[36:39], s10 offen sc1
    buffer_load_dwordx4 v[68:71], v118, s[36:39], s13 offen sc1
    s_cmp_lg_u32 s58, 0
    s_cbranch_scc1 L_NOK0
    s_mov_b32 exec_lo, 0x00010001
    s_mov_b32 exec_hi, 0x00010001
    v_sub_u32 v117, 2048, v116
    v_bfe_u32 v119, v117, 8, 2
    v_lshlrev_b32 v118, 4, v119
    v_bfe_u32 v119, v117, 6, 2
    v_lshl_add_u32 v118, v119, 1, v118
    v_bfe_u32 v119, v117, 10, 1
    v_lshl_add_u32 v118, v119, 3, v118
    buffer_load_ushort v224, v118, s[36:39], s8 offen sc1
    buffer_load_ushort v232, v118, s[36:39], s9 offen sc1
    buffer_load_ushort v240, v118, s[36:39], s10 offen sc1
    buffer_load_ushort v248, v118, s[36:39], s13 offen sc1
    v_sub_u32 v117, 1984, v116
    v_bfe_u32 v119, v117, 8, 2
    v_lshlrev_b32 v118, 4, v119
    v_bfe_u32 v119, v117, 6, 2
    v_lshl_add_u32 v118, v119, 1, v118
    v_bfe_u32 v119, v117, 10, 1
    v_lshl_add_u32 v118, v119, 3, v118
    buffer_load_ushort v225, v118, s[36:39], s8 offen sc1
    buffer_load_ushort v233, v118, s[36:39], s9 offen sc1
    buffer_load_ushort v241, v118, s[36:39], s10 offen sc1
    buffer_load_ushort v249, v118, s[36:39], s13 offen sc1
    v_sub_u32 v117, 1920, v116
    v_bfe_u32 v119, v117, 8, 2
    v_lshlrev_b32 v118, 4, v119
    v_bfe_u32 v119, v117, 6, 2
    v_lshl_add_u32 v118, v119, 1, v118
    v_bfe_u32 v119, v117, 10, 1
    v_lshl_add_u32 v118, v119, 3, v118
    buffer_load_ushort v226, v118, s[36:39], s8 offen sc1
    buffer_load_ushort v234, v118, s[36:39], s9 offen sc1
    buffer_load_ushort v242, v118, s[36:39], s10 offen sc1
    buffer_load_ushort v250, v118, s[36:39], s13 offen sc1
    v_sub_u32 v117, 1856, v116
    v_bfe_u32 v119, v117, 8, 2
    v_lshlrev_b32 v118, 4, v119
    v_bfe_u32 v119, v117, 6, 2
    v_lshl_add_u32 v118, v119, 1, v118
    v_bfe_u32 v119, v117, 10, 1
    v_lshl_add_u32 v118, v119, 3, v118
    buffer_load_ushort v227, v118, s[36:39], s8 offen sc1
    buffer_load_ushort v235, v118, s[36:39], s9 offen sc1
    buffer_load_ushort v243, v118, s[36:39], s10 offen sc1
    buffer_load_ushort v251, v118, s[36:39], s13 offen sc1
    v_sub_u32 v117, 1024, v116
    v_bfe_u32 v119, v117, 8, 2
    v_lshlrev_b32 v118, 4, v119
    v_bfe_u32 v119, v117, 6, 2
    v_lshl_add_u32 v118, v119, 1, v118
    v_bfe_u32 v119, v117, 10, 1
    v_lshl_add_u32 v118, v119, 3, v118
    buffer_load_ushort v228, v118, s[36:39], s8 offen sc1
    buffer_load_ushort v236, v118, s[36:39], s9 offen sc1
    buffer_load_ushort v244, v118, s[36:39], s10 offen sc1
    buffer_load_ushort v252, v118, s[36:39], s13 offen sc1
    v_sub_u32 v117, 960, v116
    v_bfe_u32 v119, v117, 8, 2
    v_lshlrev_b32 v118, 4, v119
    v_bfe_u32 v119, v117, 6, 2
    v_lshl_add_u32 v118, v119, 1, v118
    v_bfe_u32 v119, v117, 10, 1
    v_lshl_add_u32 v118, v119, 3, v118
    buffer_load_ushort v229, v118, s[36:39], s8 offen sc1
    buffer_load_ushort v237, v118, s[36:39], s9 offen sc1
    buffer_load_ushort v245, v118, s[36:39], s10 offen sc1
    buffer_load_ushort v253, v118, s[36:39], s13 offen sc1
    v_sub_u32 v117, 896, v116
    v_bfe_u32 v119, v117, 8, 2
    v_lshlrev_b32 v118, 4, v119
    v_bfe_u32 v119, v117, 6, 2
    v_lshl_add_u32 v118, v119, 1, v118
    v_bfe_u32 v119, v117, 10, 1
    v_lshl_add_u32 v118, v119, 3, v118
    buffer_load_ushort v230, v118, s[36:39], s8 offen sc1
    buffer_load_ushort v238, v118, s[36:39], s9 offen sc1
    buffer_load_ushort v246, v118, s[36:39], s10 offen sc1
    buffer_load_ushort v254, v118, s[36:39], s13 offen sc1
    v_sub_u32 v117, 832, v116
    v_bfe_u32 v119, v117, 8, 2
    v_lshlrev_b32 v118, 4, v119
    v_bfe_u32 v119, v117, 6, 2
    v_lshl_add_u32 v118, v119, 1, v118
    v_bfe_u32 v119, v117, 10, 1
    v_lshl_add_u32 v118, v119, 3, v118
    buffer_load_ushort v231, v118, s[36:39], s8 offen sc1
    buffer_load_ushort v239, v118, s[36:39], s9 offen sc1
    buffer_load_ushort v247, v118, s[36:39], s10 offen sc1
    buffer_load_ushort v255, v118, s[36:39], s13 offen sc1
    s_mov_b64 exec, -1
L_NOK0:
    s_waitcnt vmcnt(0)
    s_lshl_b32 s11, s58, 13
    s_add_u32 s11, s11, 104448
    v_add_u32 v119, s11, v107
    ds_write_b128 v119, v[128:131]
    ds_write_b128 v119, v[132:135] offset:1024
    s_mov_b64 exec, 1
    ds_add_u32 v127, v124 offset:28
    s_mov_b64 exec, -1
    v_lshlrev_b32 v79, 16, v56
    v_and_b32 v78, 0xffff0000, v56
    v_lshlrev_b32 v77, 16, v57
    v_and_b32 v76, 0xffff0000, v57
    v_lshlrev_b32 v75, 16, v58
    v_and_b32 v74, 0xffff0000, v58
    v_lshlrev_b32 v73, 16, v59
    v_and_b32 v72, 0xffff0000, v59
    v_lshlrev_b32 v87, 16, v60
    v_and_b32 v86, 0xffff0000, v60
    v_lshlrev_b32 v85, 16, v61
    v_and_b32 v84, 0xffff0000, v61
    v_lshlrev_b32 v83, 16, v62
    v_and_b32 v82, 0xffff0000, v62
    v_lshlrev_b32 v81, 16, v63
    v_and_b32 v80, 0xffff0000, v63
    v_lshlrev_b32 v95, 16, v64
    v_and_b32 v94, 0xffff0000, v64
    v_lshlrev_b32 v93, 16, v65
    v_and_b32 v92, 0xffff0000, v65
    v_lshlrev_b32 v91, 16, v66
    v_and_b32 v90, 0xffff0000, v66
    v_lshlrev_b32 v89, 16, v67
    v_and_b32 v88, 0xffff0000, v67
    v_lshlrev_b32 v103, 16, v68
    v_and_b32 v102, 0xffff0000, v68
    v_lshlrev_b32 v101, 16, v69
    v_and_b32 v100, 0xffff0000, v69
    v_lshlrev_b32 v99, 16, v70
    v_and_b32 v98, 0xffff0000, v70
    v_lshlrev_b32 v97, 16, v71
    v_and_b32 v96, 0xffff0000, v71
    s_cmp_lg_u32 s58, 0
    s_cbranch_scc1 L_NOK1
    s_mov_b32 exec_lo, 0x00010001
    s_mov_b32 exec_hi, 0x00010001
    v_lshlrev_b32 v72, 16, v224
    v_lshlrev_b32 v73, 16, v225
    v_lshlrev_b32 v74, 16, v226
    v_lshlrev_b32 v75, 16, v227
    v_lshlrev_b32 v76, 16, v228
    v_lshlrev_b32 v77, 16, v229
    v_lshlrev_b32 v78, 16, v230
    v_lshlrev_b32 v79, 16, v231
    v_lshlrev_b32 v80, 16, v232
    v_lshlrev_b32 v81, 16, v233
    v_lshlrev_b32 v82, 16, v234
    v_lshlrev_b32 v83, 16, v235
    v_lshlrev_b32 v84, 16, v236
    v_lshlrev_b32 v85, 16, v237
    v_lshlrev_b32 v86, 16, v238
    v_lshlrev_b32 v87, 16, v239
    v_lshlrev_b32 v88, 16, v240
    v_lshlrev_b32 v89, 16, v241
    v_lshlrev_b32 v90, 16, v242
    v_lshlrev_b32 v91, 16, v243
    v_lshlrev_b32 v92, 16, v244
    v_lshlrev_b32 v93, 16, v245
    v_lshlrev_b32 v94, 16, v246
    v_lshlrev_b32 v95, 16, v247
    v_lshlrev_b32 v96, 16, v248
    v_lshlrev_b32 v97, 16, v249
    v_lshlrev_b32 v98, 16, v250
    v_lshlrev_b32 v99, 16, v251
    v_lshlrev_b32 v100, 16, v252
    v_lshlrev_b32 v101, 16, v253
    v_lshlrev_b32 v102, 16, v254
    v_lshlrev_b32 v103, 16, v255
    s_mov_b64 exec, -1
L_NOK1:
    v_lshlrev_b32 v0, 16, v136
    v_and_b32 v1, 0xffff0000, v136
    v_lshlrev_b32 v2, 16, v137
    v_and_b32 v3, 0xffff0000, v137
    v_lshlrev_b32 v4, 16, v138
    v_and_b32 v5, 0xffff0000, v138
    v_lshlrev_b32 v6, 16, v139
    v_and_b32 v7, 0xffff0000, v139
    v_lshlrev_b32 v8, 16, v140
    v_and_b32 v9, 0xffff0000, v140
    v_lshlrev_b32 v10, 16, v141
    v_and_b32 v11, 0xffff0000, v141
    v_lshlrev_b32 v12, 16, v142
    v_and_b32 v13, 0xffff0000, v142
    v_lshlrev_b32 v14, 16, v143
    v_and_b32 v15, 0xffff0000, v143
    v_add_f32 v0, v0, v72
    v_sub_f32 v8, v8, v80
    v_add_f32 v1, v1, v73
    v_sub_f32 v9, v9, v81
    v_add_f32 v2, v2, v74
    v_sub_f32 v10, v10, v82
    v_add_f32 v3, v3, v75
    v_sub_f32 v11, v11, v83
    v_add_f32 v4, v4, v76
    v_sub_f32 v12, v12, v84
    v_add_f32 v5, v5, v77
    v_sub_f32 v13, v13, v85
    v_add_f32 v6, v6, v78
    v_sub_f32 v14, v14, v86
    v_add_f32 v7, v7, v79
    v_sub_f32 v15, v15, v87
    v_mul_f32 v0, 0x35000000, v0
    v_mul_f32 v1, 0x35000000, v1
    v_mul_f32 v2, 0x35000000, v2
    v_mul_f32 v3, 0x35000000, v3
    v_mul_f32 v4, 0x35000000, v4
    v_mul_f32 v5, 0x35000000, v5
    v_mul_f32 v6, 0x35000000, v6
    v_mul_f32 v7, 0x35000000, v7
    v_mul_f32 v8, 0x35000000, v8
    v_mul_f32 v9, 0x35000000, v9
    v_mul_f32 v10, 0x35000000, v10
    v_mul_f32 v11, 0x35000000, v11
    v_mul_f32 v12, 0x35000000, v12
    v_mul_f32 v13, 0x35000000, v13
    v_mul_f32 v14, 0x35000000, v14
    v_mul_f32 v15, 0x35000000, v15
    v_lshlrev_b32 v16, 16, v32
    v_and_b32 v17, 0xffff0000, v32
    v_lshlrev_b32 v18, 16, v33
    v_and_b32 v19, 0xffff0000, v33
    v_lshlrev_b32 v20, 16, v34
    v_and_b32 v21, 0xffff0000, v34
    v_lshlrev_b32 v22, 16, v35
    v_and_b32 v23, 0xffff0000, v35
    v_lshlrev_b32 v24, 16, v36
    v_and_b32 v25, 0xffff0000, v36
    v_lshlrev_b32 v26, 16, v37
    v_and_b32 v27, 0xffff0000, v37
    v_lshlrev_b32 v28, 16, v38
    v_and_b32 v29, 0xffff0000, v38
    v_lshlrev_b32 v30, 16, v39
    v_and_b32 v31, 0xffff0000, v39
    v_add_f32 v16, v16, v88
    v_sub_f32 v24, v24, v96
    v_add_f32 v17, v17, v89
    v_sub_f32 v25, v25, v97
    v_add_f32 v18, v18, v90
    v_sub_f32 v26, v26, v98
    v_add_f32 v19, v19, v91
    v_sub_f32 v27, v27, v99
    v_add_f32 v20, v20, v92
    v_sub_f32 v28, v28, v100
    v_add_f32 v21, v21, v93
    v_sub_f32 v29, v29, v101
    v_add_f32 v22, v22, v94
    v_sub_f32 v30, v30, v102
    v_add_f32 v23, v23, v95
    v_sub_f32 v31, v31, v103
    v_mul_f32 v16, 0x35000000, v16
    v_mul_f32 v17, 0x35000000, v17
    v_mul_f32 v18, 0x35000000, v18
    v_mul_f32 v19, 0x35000000, v19
    v_mul_f32 v20, 0x35000000, v20
    v_mul_f32 v21, 0x35000000, v21
    v_mul_f32 v22, 0x35000000, v22
    v_mul_f32 v23, 0x35000000, v23
    v_mul_f32 v24, 0x35000000, v24
    v_mul_f32 v25, 0x35000000, v25
    v_mul_f32 v26, 0x35000000, v26
    v_mul_f32 v27, 0x35000000, v27
    v_mul_f32 v28, 0x35000000, v28
    v_mul_f32 v29, 0x35000000, v29
    v_mul_f32 v30, 0x35000000, v30
    v_mul_f32 v31, 0x35000000, v31
L_WDONE:
    s_setprio 3
    s_mov_b32 s6, 0
L_LW_X:
    ds_read_b32 v48, v127 offset:28
    s_add_u32 s6, s6, 1
    s_waitcnt lgkmcnt(0)
    v_readfirstlane_b32 s7, v48
    s_cmp_gt_u32 s6, 0x40000
    s_cbranch_scc1 L_LWD_X
    s_cmp_ge_u32 s7, 4
    s_cbranch_scc1 L_LWD_X
    s_sleep 1
    s_branch L_LW_X
L_LWD_X:
    v_add_u32 v104, 104448, v107
    ds_read_b128 v[72:75], v104 offset:0
    ds_read_b128 v[76:79], v104 offset:1024
    ds_read_b128 v[80:83], v104 offset:8192
    ds_read_b128 v[84:87], v104 offset:9216
    ds_read_b128 v[88:91], v104 offset:16384
    ds_read_b128 v[92:95], v104 offset:17408
    ds_read_b128 v[96:99], v104 offset:24576
    ds_read_b128 v[100:103], v104 offset:25600
    s_getreg_b32 s7, hwreg(HW_REG_IB_STS, 0, 4)
    s_or_b32 s7, s7, s66
    s_cbranch_scc1 L_CP_1
    s_mov_b32 s66, 1
    v_mov_b32 v116, 0
    v_mov_b32 v117, s56
    s_mov_b64 exec, 1
    buffer_store_dword v117, v116, s[36:39], s5 offen sc1
    s_mov_b64 exec, -1
L_CP_1:
    s_waitcnt lgkmcnt(0)
    s_cmp_eq_u32 s16, 0
    s_cbranch_scc1 L_FSPEC
    v_mfma_f32_16x16x32_bf16 v[32:35], v[72:75], v[144:147], 0
    v_mfma_f32_16x16x32_bf16 v[40:43], v[72:75], v[152:155], 0
    v_mfma_f32_16x16x32_bf16 v[32:35], v[88:91], v[148:151], v[32:35]
    v_mfma_f32_16x16x32_bf16 v[40:43], v[88:91], v[144:147], v[40:43]
    v_mfma_f32_16x16x32_bf16 v[36:39], v[80:83], v[144:147], 0
    v_mfma_f32_16x16x32_bf16 v[44:47], v[80:83], v[152:155], 0
    v_mfma_f32_16x16x32_bf16 v[36:39], v[96:99], v[148:151], v[36:39]
    v_mfma_f32_16x16x32_bf16 v[44:47], v[96:99], v[144:147], v[44:47]
    v_mfma_f32_16x16x32_bf16 v[32:35], v[76:79], v[156:159], v[32:35]
    v_mfma_f32_16x16x32_bf16 v[40:43], v[76:79], v[164:167], v[40:43]
    v_mfma_f32_16x16x32_bf16 v[32:35], v[92:95], v[160:163], v[32:35]
    v_mfma_f32_16x16x32_bf16 v[40:43], v[92:95], v[156:159], v[40:43]
    v_mfma_f32_16x16x32_bf16 v[36:39], v[84:87], v[156:159], v[36:39]
    v_mfma_f32_16x16x32_bf16 v[44:47], v[84:87], v[164:167], v[44:47]
    v_mfma_f32_16x16x32_bf16 v[36:39], v[100:103], v[160:163], v[36:39]
    v_mfma_f32_16x16x32_bf16 v[44:47], v[100:103], v[156:159], v[44:47]
    s_getreg_b32 s7, hwreg(HW_REG_IB_STS, 0, 4)
    s_or_b32 s7, s7, s66
    s_cbranch_scc1 L_CP_2
    s_mov_b32 s66, 1
    v_mov_b32 v116, 0
    v_mov_b32 v117, s56
    s_mov_b64 exec, 1
    buffer_store_dword v117, v116, s[36:39], s5 offen sc1
    s_mov_b64 exec, -1
L_CP_2:
    v_mul_f32 v56, v32, v192
    v_mul_f32 v64, v40, v192
    v_mul_f32 v57, v33, v193
    v_mul_f32 v65, v41, v193
    v_mul_f32 v58, v34, v194
    v_mul_f32 v66, v42, v194
    v_mul_f32 v59, v35, v195
    v_mul_f32 v67, v43, v195
    v_mul_f32 v60, v36, v196
    v_mul_f32 v68, v44, v196
    v_mul_f32 v61, v37, v197
    v_mul_f32 v69, v45, v197
    v_mul_f32 v62, v38, v198
    v_mul_f32 v70, v46, v198
    v_mul_f32 v63, v39, v199
    v_mul_f32 v71, v47, v199
    v_fma_f32 v56, v40, v200, v56
    v_fma_f32 v64, -v32, v200, v64
    v_fma_f32 v57, v41, v201, v57
    v_fma_f32 v65, -v33, v201, v65
    v_fma_f32 v58, v42, v202, v58
    v_fma_f32 v66, -v34, v202, v66
    v_fma_f32 v59, v43, v203, v59
    v_fma_f32 v67, -v35, v203, v67
    v_fma_f32 v60, v44, v204, v60
    v_fma_f32 v68, -v36, v204, v68
    v_fma_f32 v61, v45, v205, v61
    v_fma_f32 v69, -v37, v205, v69
    v_fma_f32 v62, v46, v206, v62
    v_fma_f32 v70, -v38, v206, v70
    v_fma_f32 v63, v47, v207, v63
    v_fma_f32 v71, -v39, v207, v71
    v_cvt_pk_bf16_f32 v48, v56, v57
    v_cvt_pk_bf16_f32 v49, v58, v59
    v_cvt_pk_bf16_f32 v50, v60, v61
    v_cvt_pk_bf16_f32 v51, v62, v63
    v_cvt_pk_bf16_f32 v52, v64, v65
    v_cvt_pk_bf16_f32 v53, v66, v67
    v_cvt_pk_bf16_f32 v54, v68, v69
    v_cvt_pk_bf16_f32 v55, v70, v71
    s_getreg_b32 s7, hwreg(HW_REG_IB_STS, 0, 4)
    s_or_b32 s7, s7, s66
    s_cbranch_scc1 L_CP_3
    s_mov_b32 s66, 1
    v_mov_b32 v116, 0
    v_mov_b32 v117, s56
    s_mov_b64 exec, 1
    buffer_store_dword v117, v116, s[36:39], s5 offen sc1
    s_mov_b64 exec, -1
L_CP_3:
    v_mfma_f32_16x16x32_bf16 v[32:35], v[168:171], v[48:51], 0
    v_mfma_f32_16x16x32_bf16 v[40:43], v[168:171], v[52:55], 0
    v_mfma_f32_16x16x32_bf16 v[36:39], v[180:183], v[48:51], 0
    v_mfma_f32_16x16x32_bf16 v[44:47], v[180:183], v[52:55], 0
    v_mfma_f32_16x16x32_bf16 v[32:35], v[172:175], v[52:55], v[32:35]
    v_mfma_f32_16x16x32_bf16 v[40:43], v[176:179], v[48:51], v[40:43]
    v_mfma_f32_16x16x32_bf16 v[36:39], v[184:187], v[52:55], v[36:39]
    v_mfma_f32_16x16x32_bf16 v[44:47], v[188:191], v[48:51], v[44:47]
    s_getreg_b32 s7, hwreg(HW_REG_IB_STS, 0, 4)
    s_or_b32 s7, s7, s66
    s_nop 1
    s_cbranch_scc1 L_CP_4
    s_mov_b32 s66, 1
    v_mov_b32 v116, 0
    v_mov_b32 v117, s56
    s_mov_b64 exec, 1
    buffer_store_dword v117, v116, s[36:39], s5 offen sc1
    s_mov_b64 exec, -1
L_CP_4:
    v_mul_f32 v56, v32, v0
    v_mul_f32 v64, v40, v0
    v_mul_f32 v57, v33, v1
    v_mul_f32 v65, v41, v1
    v_mul_f32 v58, v34, v2
    v_mul_f32 v66, v42, v2
    v_mul_f32 v59, v35, v3
    v_mul_f32 v67, v43, v3
    v_mul_f32 v60, v36, v4
    v_mul_f32 v68, v44, v4
    v_mul_f32 v61, v37, v5
    v_mul_f32 v69, v45, v5
    v_mul_f32 v62, v38, v6
    v_mul_f32 v70, v46, v6
    v_mul_f32 v63, v39, v7
    v_mul_f32 v71, v47, v7
    v_fma_f32 v56, -v40, v8, v56
    v_fmac_f32 v64, v32, v8
    v_fma_f32 v57, -v41, v9, v57
    v_fmac_f32 v65, v33, v9
    v_fma_f32 v58, -v42, v10, v58
    v_fmac_f32 v66, v34, v10
    v_fma_f32 v59, -v43, v11, v59
    v_fmac_f32 v67, v35, v11
    v_fma_f32 v60, -v44, v12, v60
    v_fmac_f32 v68, v36, v12
    v_fma_f32 v61, -v45, v13, v61
    v_fmac_f32 v69, v37, v13
    v_fma_f32 v62, -v46, v14, v62
    v_fmac_f32 v70, v38, v14
    v_fma_f32 v63, -v47, v15, v63
    v_fmac_f32 v71, v39, v15
    s_branch L_FINV
L_FSPEC:
    v_mfma_f32_16x16x32_bf16 v[32:35], v[72:75], v[144:147], 0
    v_mfma_f32_16x16x32_bf16 v[40:43], v[72:75], v[152:155], 0
    v_mfma_f32_16x16x32_bf16 v[36:39], v[80:83], v[144:147], 0
    v_mfma_f32_16x16x32_bf16 v[44:47], v[80:83], v[152:155], 0
    v_mfma_f32_16x16x32_bf16 v[32:35], v[76:79], v[156:159], v[32:35]
    v_mfma_f32_16x16x32_bf16 v[40:43], v[76:79], v[164:167], v[40:43]
    v_mfma_f32_16x16x32_bf16 v[36:39], v[84:87], v[156:159], v[36:39]
    v_mfma_f32_16x16x32_bf16 v[44:47], v[84:87], v[164:167], v[44:47]
    s_getreg_b32 s7, hwreg(HW_REG_IB_STS, 0, 4)
    s_or_b32 s7, s7, s66
    s_nop 1
    s_cbranch_scc1 L_CP_5
    s_mov_b32 s66, 1
    v_mov_b32 v116, 0
    v_mov_b32 v117, s56
    s_mov_b64 exec, 1
    buffer_store_dword v117, v116, s[36:39], s5 offen sc1
    s_mov_b64 exec, -1
L_CP_5:
    v_mul_f32 v56, v32, v192
    v_mul_f32 v64, v40, v192
    v_mul_f32 v57, v33, v193
    v_mul_f32 v65, v41, v193
    v_mul_f32 v58, v34, v194
    v_mul_f32 v66, v42, v194
    v_mul_f32 v59, v35, v195
    v_mul_f32 v67, v43, v195
    v_mul_f32 v60, v36, v196
    v_mul_f32 v68, v44, v196
    v_mul_f32 v61, v37, v197
    v_mul_f32 v69, v45, v197
    v_mul_f32 v62, v38, v198
    v_mul_f32 v70, v46, v198
    v_mul_f32 v63, v39, v199
    v_mul_f32 v71, v47, v199
    v_fma_f32 v56, v40, v200, v56
    v_fma_f32 v64, -v32, v200, v64
    v_fma_f32 v57, v41, v201, v57
    v_fma_f32 v65, -v33, v201, v65
    v_fma_f32 v58, v42, v202, v58
    v_fma_f32 v66, -v34, v202, v66
    v_fma_f32 v59, v43, v203, v59
    v_fma_f32 v67, -v35, v203, v67
    v_fma_f32 v60, v44, v204, v60
    v_fma_f32 v68, -v36, v204, v68
    v_fma_f32 v61, v45, v205, v61
    v_fma_f32 v69, -v37, v205, v69
    v_fma_f32 v62, v46, v206, v62
    v_fma_f32 v70, -v38, v206, v70
    v_fma_f32 v63, v47, v207, v63
    v_fma_f32 v71, -v39, v207, v71
    v_cvt_pk_bf16_f32 v48, v56, v57
    v_cvt_pk_bf16_f32 v49, v58, v59
    v_cvt_pk_bf16_f32 v50, v60, v61
    v_cvt_pk_bf16_f32 v51, v62, v63
    v_cvt_pk_bf16_f32 v52, v64, v65
    v_cvt_pk_bf16_f32 v53, v66, v67
    v_cvt_pk_bf16_f32 v54, v68, v69
    v_cvt_pk_bf16_f32 v55, v70, v71
    s_getreg_b32 s7, hwreg(HW_REG_IB_STS, 0, 4)
    s_or_b32 s7, s7, s66
    s_cbranch_scc1 L_CP_6
    s_mov_b32 s66, 1
    v_mov_b32 v116, 0
    v_mov_b32 v117, s56
    s_mov_b64 exec, 1
    buffer_store_dword v117, v116, s[36:39], s5 offen sc1
    s_mov_b64 exec, -1
L_CP_6:
    v_mfma_f32_16x16x32_bf16 v[32:35], v[168:171], v[48:51], 0
    v_mfma_f32_16x16x32_bf16 v[40:43], v[168:171], v[52:55], 0
    v_mfma_f32_16x16x32_bf16 v[36:39], v[180:183], v[48:51], 0
    v_mfma_f32_16x16x32_bf16 v[44:47], v[180:183], v[52:55], 0
    v_mfma_f32_16x16x32_bf16 v[32:35], v[172:175], v[52:55], v[32:35]
    v_mfma_f32_16x16x32_bf16 v[40:43], v[176:179], v[48:51], v[40:43]
    v_mfma_f32_16x16x32_bf16 v[36:39], v[184:187], v[52:55], v[36:39]
    v_mfma_f32_16x16x32_bf16 v[44:47], v[188:191], v[48:51], v[44:47]
    s_getreg_b32 s7, hwreg(HW_REG_IB_STS, 0, 4)
    s_or_b32 s7, s7, s66
    s_nop 1
    s_cbranch_scc1 L_CP_7
    s_mov_b32 s66, 1
    v_mov_b32 v116, 0
    v_mov_b32 v117, s56
    s_mov_b64 exec, 1
    buffer_store_dword v117, v116, s[36:39], s5 offen sc1
    s_mov_b64 exec, -1
L_CP_7:
    v_mul_f32 v56, v32, v0
    v_mul_f32 v64, v40, v0
    v_mul_f32 v57, v33, v1
    v_mul_f32 v65, v41, v1
    v_mul_f32 v58, v34, v2
    v_mul_f32 v66, v42, v2
    v_mul_f32 v59, v35, v3
    v_mul_f32 v67, v43, v3
    v_mul_f32 v60, v36, v4
    v_mul_f32 v68, v44, v4
    v_mul_f32 v61, v37, v5
    v_mul_f32 v69, v45, v5
    v_mul_f32 v62, v38, v6
    v_mul_f32 v70, v46, v6
    v_mul_f32 v63, v39, v7
    v_mul_f32 v71, v47, v7
    v_fma_f32 v56, -v40, v8, v56
    v_fmac_f32 v64, v32, v8
    v_fma_f32 v57, -v41, v9, v57
    v_fmac_f32 v65, v33, v9
    v_fma_f32 v58, -v42, v10, v58
    v_fmac_f32 v66, v34, v10
    v_fma_f32 v59, -v43, v11, v59
    v_fmac_f32 v67, v35, v11
    v_fma_f32 v60, -v44, v12, v60
    v_fmac_f32 v68, v36, v12
    v_fma_f32 v61, -v45, v13, v61
    v_fmac_f32 v69, v37, v13
    v_fma_f32 v62, -v46, v14, v62
    v_fmac_f32 v70, v38, v14
    v_fma_f32 v63, -v47, v15, v63
    v_fmac_f32 v71, v39, v15
    v_mfma_f32_16x16x32_bf16 v[32:35], v[88:91], v[148:151], 0
    v_mfma_f32_16x16x32_bf16 v[40:43], v[88:91], v[144:147], 0
    v_mfma_f32_16x16x32_bf16 v[36:39], v[96:99], v[148:151], 0
    v_mfma_f32_16x16x32_bf16 v[44:47], v[96:99], v[144:147], 0
    v_mfma_f32_16x16x32_bf16 v[32:35], v[92:95], v[160:163], v[32:35]
    v_mfma_f32_16x16x32_bf16 v[40:43], v[92:95], v[156:159], v[40:43]
    v_mfma_f32_16x16x32_bf16 v[36:39], v[100:103], v[160:163], v[36:39]
    v_mfma_f32_16x16x32_bf16 v[44:47], v[100:103], v[156:159], v[44:47]
    s_getreg_b32 s7, hwreg(HW_REG_IB_STS, 0, 4)
    s_or_b32 s7, s7, s66
    s_nop 1
    s_cbranch_scc1 L_CP_8
    s_mov_b32 s66, 1
    v_mov_b32 v116, 0
    v_mov_b32 v117, s56
    s_mov_b64 exec, 1
    buffer_store_dword v117, v116, s[36:39], s5 offen sc1
    s_mov_b64 exec, -1
L_CP_8:
    v_mul_f32 v0, v32, v192
    v_mul_f32 v8, v40, v192
    v_mul_f32 v1, v33, v193
    v_mul_f32 v9, v41, v193
    v_mul_f32 v2, v34, v194
    v_mul_f32 v10, v42, v194
    v_mul_f32 v3, v35, v195
    v_mul_f32 v11, v43, v195
    v_mul_f32 v4, v36, v196
    v_mul_f32 v12, v44, v196
    v_mul_f32 v5, v37, v197
    v_mul_f32 v13, v45, v197
    v_mul_f32 v6, v38, v198
    v_mul_f32 v14, v46, v198
    v_mul_f32 v7, v39, v199
    v_mul_f32 v15, v47, v199
    v_fma_f32 v0, v40, v200, v0
    v_fma_f32 v8, -v32, v200, v8
    v_fma_f32 v1, v41, v201, v1
    v_fma_f32 v9, -v33, v201, v9
    v_fma_f32 v2, v42, v202, v2
    v_fma_f32 v10, -v34, v202, v10
    v_fma_f32 v3, v43, v203, v3
    v_fma_f32 v11, -v35, v203, v11
    v_fma_f32 v4, v44, v204, v4
    v_fma_f32 v12, -v36, v204, v12
    v_fma_f32 v5, v45, v205, v5
    v_fma_f32 v13, -v37, v205, v13
    v_fma_f32 v6, v46, v206, v6
    v_fma_f32 v14, -v38, v206, v14
    v_fma_f32 v7, v47, v207, v7
    v_fma_f32 v15, -v39, v207, v15
    v_cvt_pk_bf16_f32 v48, v0, v1
    v_cvt_pk_bf16_f32 v49, v2, v3
    v_cvt_pk_bf16_f32 v50, v4, v5
    v_cvt_pk_bf16_f32 v51, v6, v7
    v_cvt_pk_bf16_f32 v52, v8, v9
    v_cvt_pk_bf16_f32 v53, v10, v11
    v_cvt_pk_bf16_f32 v54, v12, v13
    v_cvt_pk_bf16_f32 v55, v14, v15
    s_getreg_b32 s7, hwreg(HW_REG_IB_STS, 0, 4)
    s_or_b32 s7, s7, s66
    s_cbranch_scc1 L_CP_9
    s_mov_b32 s66, 1
    v_mov_b32 v116, 0
    v_mov_b32 v117, s56
    s_mov_b64 exec, 1
    buffer_store_dword v117, v116, s[36:39], s5 offen sc1
    s_mov_b64 exec, -1
L_CP_9:
    v_mfma_f32_16x16x32_bf16 v[32:35], v[168:171], v[48:51], 0
    v_mfma_f32_16x16x32_bf16 v[40:43], v[168:171], v[52:55], 0
    v_mfma_f32_16x16x32_bf16 v[36:39], v[180:183], v[48:51], 0
    v_mfma_f32_16x16x32_bf16 v[44:47], v[180:183], v[52:55], 0
    v_mfma_f32_16x16x32_bf16 v[32:35], v[172:175], v[52:55], v[32:35]
    v_mfma_f32_16x16x32_bf16 v[40:43], v[176:179], v[48:51], v[40:43]
    v_mfma_f32_16x16x32_bf16 v[36:39], v[184:187], v[52:55], v[36:39]
    v_mfma_f32_16x16x32_bf16 v[44:47], v[188:191], v[48:51], v[44:47]
    s_getreg_b32 s7, hwreg(HW_REG_IB_STS, 0, 4)
    s_or_b32 s7, s7, s66
    s_nop 1
    s_cbranch_scc1 L_CP_10
    s_mov_b32 s66, 1
    v_mov_b32 v116, 0
    v_mov_b32 v117, s56
    s_mov_b64 exec, 1
    buffer_store_dword v117, v116, s[36:39], s5 offen sc1
    s_mov_b64 exec, -1
L_CP_10:
    v_fmac_f32 v56, v32, v16
    v_fmac_f32 v64, v40, v16
    v_fmac_f32 v57, v33, v17
    v_fmac_f32 v65, v41, v17
    v_fmac_f32 v58, v34, v18
    v_fmac_f32 v66, v42, v18
    v_fmac_f32 v59, v35, v19
    v_fmac_f32 v67, v43, v19
    v_fmac_f32 v60, v36, v20
    v_fmac_f32 v68, v44, v20
    v_fmac_f32 v61, v37, v21
    v_fmac_f32 v69, v45, v21
    v_fmac_f32 v62, v38, v22
    v_fmac_f32 v70, v46, v22
    v_fmac_f32 v63, v39, v23
    v_fmac_f32 v71, v47, v23
    v_fma_f32 v56, -v40, v24, v56
    v_fmac_f32 v64, v32, v24
    v_fma_f32 v57, -v41, v25, v57
    v_fmac_f32 v65, v33, v25
    v_fma_f32 v58, -v42, v26, v58
    v_fmac_f32 v66, v34, v26
    v_fma_f32 v59, -v43, v27, v59
    v_fmac_f32 v67, v35, v27
    v_fma_f32 v60, -v44, v28, v60
    v_fmac_f32 v68, v36, v28
    v_fma_f32 v61, -v45, v29, v61
    v_fmac_f32 v69, v37, v29
    v_fma_f32 v62, -v46, v30, v62
    v_fmac_f32 v70, v38, v30
    v_fma_f32 v63, -v47, v31, v63
    v_fmac_f32 v71, v39, v31
L_FINV:
    s_getreg_b32 s7, hwreg(HW_REG_IB_STS, 0, 4)
    s_or_b32 s7, s7, s66
    s_cbranch_scc1 L_CP_11
    s_mov_b32 s66, 1
    v_mov_b32 v116, 0
    v_mov_b32 v117, s56
    s_mov_b64 exec, 1
    buffer_store_dword v117, v116, s[36:39], s5 offen sc1
    s_mov_b64 exec, -1
L_CP_11:
    v_cvt_pk_bf16_f32 v48, v56, v57
    v_cvt_pk_bf16_f32 v49, v58, v59
    v_cvt_pk_bf16_f32 v50, v60, v61
    v_cvt_pk_bf16_f32 v51, v62, v63
    v_cvt_pk_bf16_f32 v52, v64, v65
    v_cvt_pk_bf16_f32 v53, v66, v67
    v_cvt_pk_bf16_f32 v54, v68, v69
    v_cvt_pk_bf16_f32 v55, v70, v71
    v_mfma_f32_16x16x32_bf16 v[32:35], v[48:51], v[168:171], 0
    s_nop 0
    v_mfma_f32_16x16x32_bf16 v[40:43], v[52:55], v[168:171], 0
    v_mfma_f32_16x16x32_bf16 v[36:39], v[48:51], v[180:183], 0
    v_mfma_f32_16x16x32_bf16 v[44:47], v[52:55], v[180:183], 0
    v_mfma_f32_16x16x32_bf16 v[32:35], v[52:55], v[176:179], v[32:35]
    v_mfma_f32_16x16x32_bf16 v[40:43], v[48:51], v[172:175], v[40:43]
    v_mfma_f32_16x16x32_bf16 v[36:39], v[52:55], v[188:191], v[36:39]
    v_mfma_f32_16x16x32_bf16 v[44:47], v[48:51], v[184:187], v[44:47]
    v_mul_u32_u24 v104, 144, v125
    v_and_b32 v105, 1, v126
    v_lshl_add_u32 v105, v105, 4, v104
    v_lshrrev_b32 v0, 1, v126
    v_lshl_add_u32 v105, v0, 3, v105
    s_lshl_b32 s11, s58, 5
    v_add_u32 v105, s11, v105
    v_lshl_add_u32 v104, v126, 4, v104
    v_add_u32 v0, 4, v127
    s_getreg_b32 s7, hwreg(HW_REG_IB_STS, 0, 4)
    s_or_b32 s7, s7, s66
    s_cbranch_scc1 L_CP_12
    s_mov_b32 s66, 1
    v_mov_b32 v116, 0
    v_mov_b32 v117, s56
    s_mov_b64 exec, 1
    buffer_store_dword v117, v116, s[36:39], s5 offen sc1
    s_mov_b64 exec, -1
L_CP_12:
    v_mul_f32 v56, v32, v208
    v_mul_f32 v64, v40, v208
    v_mul_f32 v57, v33, v209
    v_mul_f32 v65, v41, v209
    v_mul_f32 v58, v34, v210
    v_mul_f32 v66, v42, v210
    v_mul_f32 v59, v35, v211
    v_mul_f32 v67, v43, v211
    v_mul_f32 v60, v36, v212
    v_mul_f32 v68, v44, v212
    v_mul_f32 v61, v37, v213
    v_mul_f32 v69, v45, v213
    v_mul_f32 v62, v38, v214
    v_mul_f32 v70, v46, v214
    v_mul_f32 v63, v39, v215
    v_mul_f32 v71, v47, v215
    v_fma_f32 v56, -v40, v216, v56
    v_fma_f32 v64, v32, v216, v64
    v_fma_f32 v57, -v41, v217, v57
    v_fma_f32 v65, v33, v217, v65
    v_fma_f32 v58, -v42, v218, v58
    v_fma_f32 v66, v34, v218, v66
    v_fma_f32 v59, -v43, v219, v59
    v_fma_f32 v67, v35, v219, v67
    v_fma_f32 v60, -v44, v220, v60
    v_fma_f32 v68, v36, v220, v68
    v_fma_f32 v61, -v45, v221, v61
    v_fma_f32 v69, v37, v221, v69
    v_fma_f32 v62, -v46, v222, v62
    v_fma_f32 v70, v38, v222, v70
    v_fma_f32 v63, -v47, v223, v63
    v_fma_f32 v71, v39, v223, v71
    v_cvt_pk_bf16_f32 v48, v56, v57
    v_cvt_pk_bf16_f32 v49, v58, v59
    v_cvt_pk_bf16_f32 v50, v60, v61
    v_cvt_pk_bf16_f32 v51, v62, v63
    v_cvt_pk_bf16_f32 v52, v64, v65
    v_cvt_pk_bf16_f32 v53, v66, v67
    v_cvt_pk_bf16_f32 v54, v68, v69
    v_cvt_pk_bf16_f32 v55, v70, v71
    s_mov_b32 s6, 0
L_LW_BH:
    ds_read_b32 v1, v127 offset:12
    s_add_u32 s6, s6, 1
    s_waitcnt lgkmcnt(0)
    v_readfirstlane_b32 s7, v1
    s_cmp_gt_u32 s6, 0x40000
    s_cbranch_scc1 L_LWD_BH
    s_cmp_ge_u32 s7, 4
    s_cbranch_scc1 L_LWD_BH
    s_sleep 1
    s_branch L_LW_BH
L_LWD_BH:
    ds_write_b64 v105, v[48:49] offset:9216
    ds_write_b64 v105, v[50:51] offset:11520
    ds_write_b64 v105, v[52:53] offset:13824
    ds_write_b64 v105, v[54:55] offset:16128
    s_mov_b64 exec, 1
    ds_add_u32 v0, v124 offset:0
    s_mov_b64 exec, -1
    s_waitcnt vmcnt(0)
    s_cmp_lg_u32 s66, 0
    s_cbranch_scc1 L_CP_13
    s_mov_b32 s66, 1
    v_mov_b32 v116, 0
    v_mov_b32 v117, s56
    s_mov_b64 exec, 1
    buffer_store_dword v117, v116, s[36:39], s5 offen sc1
    s_mov_b64 exec, -1
L_CP_13:
    s_mov_b32 s6, 0
L_LW_E:
    ds_read_b32 v48, v0 offset:0
    s_add_u32 s6, s6, 1
    s_waitcnt lgkmcnt(0)
    v_readfirstlane_b32 s7, v48
    s_cmp_gt_u32 s6, 0x40000
    s_cbranch_scc1 L_LWD_E
    s_cmp_ge_u32 s7, 4
    s_cbranch_scc1 L_LWD_E
    s_sleep 1
    s_branch L_LW_E
L_LWD_E:
    ds_read_b128 v[72:75], v104 offset:9216
    ds_read_b128 v[76:79], v104 offset:9280
    ds_read_b128 v[80:83], v104 offset:11520
    ds_read_b128 v[84:87], v104 offset:11584
    ds_read_b128 v[88:91], v104 offset:13824
    ds_read_b128 v[92:95], v104 offset:13888
    ds_read_b128 v[96:99], v104 offset:16128
    ds_read_b128 v[100:103], v104 offset:16192
    v_lshrrev_b32 v105, 1, v125
    s_mov_b32 s9, 65920
    v_mul_lo_u32 v105, v105, s9
    v_and_b32 v1, 1, v125
    v_lshl_add_u32 v105, v1, 6, v105
    v_lshl_add_u32 v105, v126, 4, v105
    s_lshl_b32 s9, s16, 7
    s_mul_i32 s10, s58, 527360
    s_add_u32 s9, s9, s10
    s_add_u32 s9, s9, 0x1100000
    s_add_u32 s11, s9, 32768
    s_lshl_b32 s5, s16, 4
    s_lshl_b32 s10, s58, 12
    s_add_u32 s5, s5, s10
    s_add_u32 s5, s5, 0x40000
    s_waitcnt lgkmcnt(0)
    s_mov_b64 exec, 1
    ds_add_u32 v127, v124 offset:8
    s_mov_b64 exec, -1
    v_mfma_f32_16x16x32_bf16 v[32:35], v[72:75], v[144:147], 0
    v_mfma_f32_16x16x32_bf16 v[40:43], v[72:75], v[148:151], 0
    v_mfma_f32_16x16x32_bf16 v[36:39], v[80:83], v[144:147], 0
    v_mfma_f32_16x16x32_bf16 v[44:47], v[80:83], v[148:151], 0
    v_mfma_f32_16x16x32_bf16 v[32:35], v[88:91], v[152:155], v[32:35]
    v_mfma_f32_16x16x32_bf16 v[40:43], v[88:91], v[144:147], v[40:43]
    v_mfma_f32_16x16x32_bf16 v[36:39], v[96:99], v[152:155], v[36:39]
    v_mfma_f32_16x16x32_bf16 v[44:47], v[96:99], v[144:147], v[44:47]
    v_mfma_f32_16x16x32_bf16 v[32:35], v[76:79], v[156:159], v[32:35]
    v_mfma_f32_16x16x32_bf16 v[40:43], v[76:79], v[160:163], v[40:43]
    v_mfma_f32_16x16x32_bf16 v[36:39], v[84:87], v[156:159], v[36:39]
    v_mfma_f32_16x16x32_bf16 v[44:47], v[84:87], v[160:163], v[44:47]
    v_mfma_f32_16x16x32_bf16 v[32:35], v[92:95], v[164:167], v[32:35]
    v_mfma_f32_16x16x32_bf16 v[40:43], v[92:95], v[156:159], v[40:43]
    v_mfma_f32_16x16x32_bf16 v[36:39], v[100:103], v[164:167], v[36:39]
    v_mfma_f32_16x16x32_bf16 v[44:47], v[100:103], v[156:159], v[44:47]
    s_nop 4
    v_cvt_pk_bf16_f32 v48, v32, v33
    v_cvt_pk_bf16_f32 v49, v34, v35
    v_cvt_pk_bf16_f32 v50, v36, v37
    v_cvt_pk_bf16_f32 v51, v38, v39
    v_cvt_pk_bf16_f32 v52, v40, v41
    v_cvt_pk_bf16_f32 v53, v42, v43
    v_cvt_pk_bf16_f32 v54, v44, v45
    v_cvt_pk_bf16_f32 v55, v46, v47
    buffer_store_dwordx4 v[48:51], v105, s[36:39], s9 offen sc1
    buffer_store_dwordx4 v[52:55], v105, s[36:39], s11 offen sc1
    s_lshl_b32 s8, s61, 2
    s_and_b32 s9, s62, 3
    s_add_u32 s8, s8, s9
    s_lshl_b32 s14, s8, 16
    s_and_b32 s15, s58, 1
    s_lshl_b32 s15, s15, 15
    s_add_u32 s14, s14, s15
    s_lshr_b32 s15, s62, 2
    s_lshl_b32 s15, s15, 7
    s_add_u32 s14, s14, s15
    s_lshr_b32 s15, s58, 1
    s_lshl_b32 s15, s15, 6
    s_add_u32 s14, s14, s15
    s_lshr_b32 s9, s57, 2
    s_lshl_b32 s15, s9, 5
    s_add_u32 s14, s14, s15
    v_and_b32 v88, 31, v106
    v_lshlrev_b32 v88, 10, v88
    v_lshrrev_b32 v108, 5, v106
    v_lshl_add_u32 v88, v108, 4, v88
    s_lshl_b32 s9, s9, 11
    s_xor_b32 s10, s58, 0
    s_and_b32 s11, s10, 1
    s_lshl_b32 s11, s11, 12
    s_lshr_b32 s10, s10, 1
    s_lshl_b32 s10, s10, 15
    s_add_u32 s10, s10, s11
    s_add_u32 s10, s10, 32768
    s_add_u32 s10, s10, s9
    v_add_u32 v108, s10, v107
    s_xor_b32 s10, s58, 1
    s_and_b32 s11, s10, 1
    s_lshl_b32 s11, s11, 12
    s_lshr_b32 s10, s10, 1
    s_lshl_b32 s10, s10, 15
    s_add_u32 s10, s10, s11
    s_add_u32 s10, s10, 40960
    s_add_u32 s10, s10, s9
    v_add_u32 v109, s10, v107
    s_xor_b32 s10, s58, 2
    s_and_b32 s11, s10, 1
    s_lshl_b32 s11, s11, 12
    s_lshr_b32 s10, s10, 1
    s_lshl_b32 s10, s10, 15
    s_add_u32 s10, s10, s11
    s_add_u32 s10, s10, 49152
    s_add_u32 s10, s10, s9
    v_add_u32 v110, s10, v107
    s_xor_b32 s10, s58, 3
    s_and_b32 s11, s10, 1
    s_lshl_b32 s11, s11, 12
    s_lshr_b32 s10, s10, 1
    s_lshl_b32 s10, s10, 15
    s_add_u32 s10, s10, s11
    s_add_u32 s10, s10, 57344
    s_add_u32 s10, s10, s9
    v_add_u32 v111, s10, v107
    s_and_b32 s10, s58, 1
    s_lshl_b32 s10, s10, 12
    s_lshr_b32 s11, s58, 1
    s_mul_i32 s11, s11, 98304
    s_add_u32 s10, s10, s11
    s_add_u32 s10, s10, s9
    s_add_u32 s11, s10, 0
    v_add_u32 v112, s11, v107
    s_add_u32 s11, s10, 8192
    v_add_u32 v113, s11, v107
    s_add_u32 s11, s10, 16384
    v_add_u32 v114, s11, v107
    s_add_u32 s11, s10, 24576
    v_add_u32 v115, s11, v107
    s_waitcnt vmcnt(0)
    v_mov_b32 v116, 0
    v_mov_b32 v117, s56
    s_mov_b64 exec, 1
    buffer_store_dword v117, v116, s[36:39], s5 offen sc1
    s_mov_b64 exec, -1
    s_lshr_b32 s9, s8, 3
    s_lshl_b32 s9, s9, 12
    s_lshl_b32 s10, s58, 10
    s_add_u32 s9, s9, s10
    s_add_u32 s9, s9, 0x40000
    v_lshlrev_b32 v104, 4, v106
    s_lshl_b32 s10, s58, 13
    s_mul_i32 s11, s8, 65920
    s_add_u32 s10, s10, s11
    s_add_u32 s10, s10, 0x1100000
    s_lshl_b32 s11, s58, 13
    v_bfe_u32 v116, v106, 4, 1
    v_lshlrev_b32 v116, 6, v116
    v_xor_b32 v116, v116, v107
    v_add_u32 v82, s11, v116
    v_add_u32 v83, s11, v107
    v_bfe_u32 v116, v106, 2, 2
    v_lshrrev_b32 v117, 5, v106
    v_lshl_add_u32 v117, v117, 3, v116
    v_lshlrev_b32 v117, 7, v117
    v_add_u32 v117, s11, v117
    v_bfe_u32 v116, v106, 4, 1
    v_lshl_add_u32 v117, v116, 3, v117
    v_and_b32 v116, 3, v106
    v_lshl_add_u32 v117, v116, 4, v117
    v_bfe_u32 v116, v106, 3, 1
    v_lshl_add_u32 v80, v116, 6, v117
    v_xor_b32 v81, 64, v80
    s_lshl_b32 s12, s58, 2
    v_add_u32 v125, s12, v127
    s_setprio 0
    s_lshr_b32 s15, s62, 2
    s_lshl_b32 s15, s15, 6
    v_lshrrev_b32 v4, 5, v106
    v_lshlrev_b32 v4, 3, v4
    s_lshl_b32 s7, s58, 6
    v_add_u32 v4, s7, v4
    v_cmp_eq_u32 vcc, 0, v4
    v_cvt_f32_u32 v4, v4
    v_and_b32 v0, 31, v106
    v_add_u32 v0, s15, v0
    s_add_u32 s15, s15, 32
    v_cvt_f32_u32 v0, v0
    v_mul_f32 v2, 0.5, v0
    v_mul_f32 v0, 0x3b000000, v0
    v_mul_f32 v1, v4, v0
    v_mul_f32 v3, 0x41800000, v0
    v_cos_f32 v3, v3
    v_cos_f32 v2, v2
    v_mov_b32 v24, v1
    v_fmamk_f32 v25, v0, 0x3f800000, v1
    v_fmamk_f32 v26, v0, 0x40000000, v1
    v_fmamk_f32 v27, v0, 0x40400000, v1
    v_fmamk_f32 v28, v0, 0x40800000, v1
    v_fmamk_f32 v29, v0, 0x40a00000, v1
    v_fmamk_f32 v30, v0, 0x40c00000, v1
    v_fmamk_f32 v31, v0, 0x40e00000, v1
    v_fmamk_f32 v32, v0, 0x41800000, v1
    v_fmamk_f32 v33, v0, 0x41880000, v1
    v_fmamk_f32 v34, v0, 0x41900000, v1
    v_fmamk_f32 v35, v0, 0x41980000, v1
    v_fmamk_f32 v36, v0, 0x41a00000, v1
    v_fmamk_f32 v37, v0, 0x41a80000, v1
    v_fmamk_f32 v38, v0, 0x41b00000, v1
    v_fmamk_f32 v39, v0, 0x41b80000, v1
    v_add_f32 v3, v3, v3
    v_cos_f32 v8, v24
    v_sin_f32 v24, v24
    v_cos_f32 v9, v25
    v_sin_f32 v25, v25
    v_cos_f32 v10, v26
    v_sin_f32 v26, v26
    v_cos_f32 v11, v27
    v_sin_f32 v27, v27
    v_cos_f32 v12, v28
    v_sin_f32 v28, v28
    v_cos_f32 v13, v29
    v_sin_f32 v29, v29
    v_cos_f32 v14, v30
    v_sin_f32 v30, v30
    v_cos_f32 v15, v31
    v_sin_f32 v31, v31
    v_cos_f32 v16, v32
    v_sin_f32 v32, v32
    v_cos_f32 v17, v33
    v_sin_f32 v33, v33
    v_cos_f32 v18, v34
    v_sin_f32 v34, v34
    v_cos_f32 v19, v35
    v_sin_f32 v35, v35
    v_cos_f32 v20, v36
    v_sin_f32 v36, v36
    v_cos_f32 v21, v37
    v_sin_f32 v37, v37
    v_cos_f32 v22, v38
    v_sin_f32 v38, v38
    v_cos_f32 v23, v39
    v_sin_f32 v39, v39
    v_sub_f32 v2, 0, v2
    v_cndmask_b32 v2, v24, v2, vcc
    v_cvt_pk_bf16_f32 v192, v8, v9
    v_cvt_pk_bf16_f32 v224, -v2, -v25
    v_cvt_pk_bf16_f32 v193, v10, v11
    v_cvt_pk_bf16_f32 v225, -v26, -v27
    v_cvt_pk_bf16_f32 v194, v12, v13
    v_cvt_pk_bf16_f32 v226, -v28, -v29
    v_cvt_pk_bf16_f32 v195, v14, v15
    v_cvt_pk_bf16_f32 v227, -v30, -v31
    v_cvt_pk_bf16_f32 v200, v16, v17
    v_cvt_pk_bf16_f32 v232, -v32, -v33
    v_cvt_pk_bf16_f32 v201, v18, v19
    v_cvt_pk_bf16_f32 v233, -v34, -v35
    v_cvt_pk_bf16_f32 v202, v20, v21
    v_cvt_pk_bf16_f32 v234, -v36, -v37
    v_cvt_pk_bf16_f32 v203, v22, v23
    v_cvt_pk_bf16_f32 v235, -v38, -v39
    v_fma_f32 v8, v3, v16, -v8
    v_fma_f32 v9, v3, v17, -v9
    v_fma_f32 v10, v3, v18, -v10
    v_fma_f32 v11, v3, v19, -v11
    v_fma_f32 v12, v3, v20, -v12
    v_fma_f32 v13, v3, v21, -v13
    v_fma_f32 v14, v3, v22, -v14
    v_fma_f32 v15, v3, v23, -v15
    v_fma_f32 v24, v3, v32, -v24
    v_fma_f32 v25, v3, v33, -v25
    v_fma_f32 v26, v3, v34, -v26
    v_fma_f32 v27, v3, v35, -v27
    v_fma_f32 v28, v3, v36, -v28
    v_fma_f32 v29, v3, v37, -v29
    v_fma_f32 v30, v3, v38, -v30
    v_fma_f32 v31, v3, v39, -v31
    v_cvt_pk_bf16_f32 v208, v8, v9
    v_cvt_pk_bf16_f32 v240, -v24, -v25
    v_cvt_pk_bf16_f32 v209, v10, v11
    v_cvt_pk_bf16_f32 v241, -v26, -v27
    v_cvt_pk_bf16_f32 v210, v12, v13
    v_cvt_pk_bf16_f32 v242, -v28, -v29
    v_cvt_pk_bf16_f32 v211, v14, v15
    v_cvt_pk_bf16_f32 v243, -v30, -v31
    v_fma_f32 v16, v3, v8, -v16
    v_fma_f32 v17, v3, v9, -v17
    v_fma_f32 v18, v3, v10, -v18
    v_fma_f32 v19, v3, v11, -v19
    v_fma_f32 v20, v3, v12, -v20
    v_fma_f32 v21, v3, v13, -v21
    v_fma_f32 v22, v3, v14, -v22
    v_fma_f32 v23, v3, v15, -v23
    v_fma_f32 v32, v3, v24, -v32
    v_fma_f32 v33, v3, v25, -v33
    v_fma_f32 v34, v3, v26, -v34
    v_fma_f32 v35, v3, v27, -v35
    v_fma_f32 v36, v3, v28, -v36
    v_fma_f32 v37, v3, v29, -v37
    v_fma_f32 v38, v3, v30, -v38
    v_fma_f32 v39, v3, v31, -v39
    v_cvt_pk_bf16_f32 v216, v16, v17
    v_cvt_pk_bf16_f32 v248, -v32, -v33
    v_cvt_pk_bf16_f32 v217, v18, v19
    v_cvt_pk_bf16_f32 v249, -v34, -v35
    v_cvt_pk_bf16_f32 v218, v20, v21
    v_cvt_pk_bf16_f32 v250, -v36, -v37
    v_cvt_pk_bf16_f32 v219, v22, v23
    v_cvt_pk_bf16_f32 v251, -v38, -v39
    v_and_b32 v0, 31, v106
    v_add_u32 v0, s15, v0
    v_cvt_f32_u32 v0, v0
    v_mul_f32 v2, 0.5, v0
    v_mul_f32 v0, 0x3b000000, v0
    v_mul_f32 v1, v4, v0
    v_mul_f32 v3, 0x41800000, v0
    v_cos_f32 v3, v3
    v_cos_f32 v2, v2
    v_mov_b32 v24, v1
    v_fmamk_f32 v25, v0, 0x3f800000, v1
    v_fmamk_f32 v26, v0, 0x40000000, v1
    v_fmamk_f32 v27, v0, 0x40400000, v1
    v_fmamk_f32 v28, v0, 0x40800000, v1
    v_fmamk_f32 v29, v0, 0x40a00000, v1
    v_fmamk_f32 v30, v0, 0x40c00000, v1
    v_fmamk_f32 v31, v0, 0x40e00000, v1
    v_fmamk_f32 v32, v0, 0x41800000, v1
    v_fmamk_f32 v33, v0, 0x41880000, v1
    v_fmamk_f32 v34, v0, 0x41900000, v1
    v_fmamk_f32 v35, v0, 0x41980000, v1
    v_fmamk_f32 v36, v0, 0x41a00000, v1
    v_fmamk_f32 v37, v0, 0x41a80000, v1
    v_fmamk_f32 v38, v0, 0x41b00000, v1
    v_fmamk_f32 v39, v0, 0x41b80000, v1
    v_add_f32 v3, v3, v3
    v_cos_f32 v8, v24
    v_sin_f32 v24, v24
    v_cos_f32 v9, v25
    v_sin_f32 v25, v25
    v_cos_f32 v10, v26
    v_sin_f32 v26, v26
    v_cos_f32 v11, v27
    v_sin_f32 v27, v27
    v_cos_f32 v12, v28
    v_sin_f32 v28, v28
    v_cos_f32 v13, v29
    v_sin_f32 v29, v29
    v_cos_f32 v14, v30
    v_sin_f32 v30, v30
    v_cos_f32 v15, v31
    v_sin_f32 v31, v31
    v_cos_f32 v16, v32
    v_sin_f32 v32, v32
    v_cos_f32 v17, v33
    v_sin_f32 v33, v33
    v_cos_f32 v18, v34
    v_sin_f32 v34, v34
    v_cos_f32 v19, v35
    v_sin_f32 v35, v35
    v_cos_f32 v20, v36
    v_sin_f32 v36, v36
    v_cos_f32 v21, v37
    v_sin_f32 v37, v37
    v_cos_f32 v22, v38
    v_sin_f32 v38, v38
    v_cos_f32 v23, v39
    v_sin_f32 v39, v39
    v_sub_f32 v2, 0, v2
    v_cndmask_b32 v2, v24, v2, vcc
    v_cvt_pk_bf16_f32 v196, v8, v9
    v_cvt_pk_bf16_f32 v228, -v2, -v25
    v_cvt_pk_bf16_f32 v197, v10, v11
    v_cvt_pk_bf16_f32 v229, -v26, -v27
    v_cvt_pk_bf16_f32 v198, v12, v13
    v_cvt_pk_bf16_f32 v230, -v28, -v29
    v_cvt_pk_bf16_f32 v199, v14, v15
    v_cvt_pk_bf16_f32 v231, -v30, -v31
    v_cvt_pk_bf16_f32 v204, v16, v17
    v_cvt_pk_bf16_f32 v236, -v32, -v33
    v_cvt_pk_bf16_f32 v205, v18, v19
    v_cvt_pk_bf16_f32 v237, -v34, -v35
    v_cvt_pk_bf16_f32 v206, v20, v21
    v_cvt_pk_bf16_f32 v238, -v36, -v37
    v_cvt_pk_bf16_f32 v207, v22, v23
    v_cvt_pk_bf16_f32 v239, -v38, -v39
    v_fma_f32 v8, v3, v16, -v8
    v_fma_f32 v9, v3, v17, -v9
    v_fma_f32 v10, v3, v18, -v10
    v_fma_f32 v11, v3, v19, -v11
    v_fma_f32 v12, v3, v20, -v12
    v_fma_f32 v13, v3, v21, -v13
    v_fma_f32 v14, v3, v22, -v14
    v_fma_f32 v15, v3, v23, -v15
    v_fma_f32 v24, v3, v32, -v24
    v_fma_f32 v25, v3, v33, -v25
    v_fma_f32 v26, v3, v34, -v26
    v_fma_f32 v27, v3, v35, -v27
    v_fma_f32 v28, v3, v36, -v28
    v_fma_f32 v29, v3, v37, -v29
    v_fma_f32 v30, v3, v38, -v30
    v_fma_f32 v31, v3, v39, -v31
    v_cvt_pk_bf16_f32 v212, v8, v9
    v_cvt_pk_bf16_f32 v244, -v24, -v25
    v_cvt_pk_bf16_f32 v213, v10, v11
    v_cvt_pk_bf16_f32 v245, -v26, -v27
    v_cvt_pk_bf16_f32 v214, v12, v13
    v_cvt_pk_bf16_f32 v246, -v28, -v29
    v_cvt_pk_bf16_f32 v215, v14, v15
    v_cvt_pk_bf16_f32 v247, -v30, -v31
    v_fma_f32 v16, v3, v8, -v16
    v_fma_f32 v17, v3, v9, -v17
    v_fma_f32 v18, v3, v10, -v18
    v_fma_f32 v19, v3, v11, -v19
    v_fma_f32 v20, v3, v12, -v20
    v_fma_f32 v21, v3, v13, -v21
    v_fma_f32 v22, v3, v14, -v22
    v_fma_f32 v23, v3, v15, -v23
    v_fma_f32 v32, v3, v24, -v32
    v_fma_f32 v33, v3, v25, -v33
    v_fma_f32 v34, v3, v26, -v34
    v_fma_f32 v35, v3, v27, -v35
    v_fma_f32 v36, v3, v28, -v36
    v_fma_f32 v37, v3, v29, -v37
    v_fma_f32 v38, v3, v30, -v38
    v_fma_f32 v39, v3, v31, -v39
    v_cvt_pk_bf16_f32 v220, v16, v17
    v_cvt_pk_bf16_f32 v252, -v32, -v33
    v_cvt_pk_bf16_f32 v221, v18, v19
    v_cvt_pk_bf16_f32 v253, -v34, -v35
    v_cvt_pk_bf16_f32 v222, v20, v21
    v_cvt_pk_bf16_f32 v254, -v36, -v37
    v_cvt_pk_bf16_f32 v223, v22, v23
    v_cvt_pk_bf16_f32 v255, -v38, -v39
    s_setprio 3
    s_mov_b32 s6, 0
L_LW_R:
    ds_read_b32 v116, v125 offset:32
    s_add_u32 s6, s6, 1
    s_waitcnt lgkmcnt(0)
    v_readfirstlane_b32 s7, v116
    s_cmp_gt_u32 s6, 0x40000
    s_cbranch_scc1 L_LWD_R
    s_cmp_ge_u32 s7, 1
    s_cbranch_scc1 L_LWD_R
    s_sleep 3
    s_branch L_LW_R
L_LWD_R:
    s_mov_b32 s6, 0
L_LW_ZX:
    ds_read_b32 v116, v127 offset:8
    s_add_u32 s6, s6, 1
    s_waitcnt lgkmcnt(0)
    v_readfirstlane_b32 s7, v116
    s_cmp_gt_u32 s6, 0x40000
    s_cbranch_scc1 L_LWD_ZX
    s_cmp_ge_u32 s7, 4
    s_cbranch_scc1 L_LWD_ZX
    s_sleep 1
    s_branch L_LW_ZX
L_LWD_ZX:
    s_mov_b32 s6, 0
L_POLL_Z:
    buffer_load_dword v0, v104, s[36:39], s9 offen sc1
    s_add_u32 s6, s6, 1
    s_cmp_gt_u32 s6, 0x8000
    s_waitcnt vmcnt(0)
    s_cbranch_scc1 L_POLLED_Z
    v_cmp_ne_u32 vcc, s56, v0
    s_cbranch_vccz L_POLLED_Z
    s_mov_b64 exec, vcc
    s_sleep 4
    s_branch L_POLL_Z
L_POLLED_Z:
    s_mov_b64 exec, -1
    buffer_load_dwordx4 v[128:131], v107, s[36:39], s10 offen offset:0 sc1
    buffer_load_dwordx4 v[132:135], v107, s[36:39], s10 offen offset:1024 sc1
    buffer_load_dwordx4 v[136:139], v107, s[36:39], s10 offen offset:2048 sc1
    buffer_load_dwordx4 v[140:143], v107, s[36:39], s10 offen offset:3072 sc1
    s_add_u32 s10, s10, 4096
    buffer_load_dwordx4 v[144:147], v107, s[36:39], s10 offen offset:0 sc1
    buffer_load_dwordx4 v[148:151], v107, s[36:39], s10 offen offset:1024 sc1
    buffer_load_dwordx4 v[152:155], v107, s[36:39], s10 offen offset:2048 sc1
    buffer_load_dwordx4 v[156:159], v107, s[36:39], s10 offen offset:3072 sc1
    s_add_u32 s10, s10, 28672
    buffer_load_dwordx4 v[160:163], v107, s[36:39], s10 offen offset:0 sc1
    buffer_load_dwordx4 v[164:167], v107, s[36:39], s10 offen offset:1024 sc1
    buffer_load_dwordx4 v[168:171], v107, s[36:39], s10 offen offset:2048 sc1
    buffer_load_dwordx4 v[172:175], v107, s[36:39], s10 offen offset:3072 sc1
    s_add_u32 s10, s10, 4096
    buffer_load_dwordx4 v[176:179], v107, s[36:39], s10 offen offset:0 sc1
    buffer_load_dwordx4 v[180:183], v107, s[36:39], s10 offen offset:1024 sc1
    buffer_load_dwordx4 v[184:187], v107, s[36:39], s10 offen offset:2048 sc1
    buffer_load_dwordx4 v[188:191], v107, s[36:39], s10 offen offset:3072 sc1
    s_setprio 3
    s_waitcnt vmcnt(14)
    ds_write_b128 v82, v[128:131] offset:0
    ds_write_b128 v82, v[132:135] offset:1024
    ds_read_b64_tr_b16 v[64:65], v80 offset:0
    ds_read_b64_tr_b16 v[66:67], v80 offset:512
    ds_read_b64_tr_b16 v[68:69], v81 offset:0
    ds_read_b64_tr_b16 v[70:71], v81 offset:512
    s_waitcnt vmcnt(12)
    ds_write_b128 v82, v[136:139] offset:2048
    ds_write_b128 v82, v[140:143] offset:3072
    ds_read_b64_tr_b16 v[72:73], v80 offset:2048
    ds_read_b64_tr_b16 v[74:75], v80 offset:2560
    ds_read_b64_tr_b16 v[76:77], v81 offset:2048
    ds_read_b64_tr_b16 v[78:79], v81 offset:2560
    s_waitcnt lgkmcnt(6)
    v_mfma_f32_32x32x16_bf16 v[0:15], v[192:195], v[64:67], 0
    s_waitcnt vmcnt(10)
    ds_write_b128 v82, v[144:147] offset:4096
    ds_write_b128 v82, v[148:151] offset:5120
    ds_read_b64_tr_b16 v[96:97], v80 offset:4096
    ds_read_b64_tr_b16 v[98:99], v80 offset:4608
    ds_read_b64_tr_b16 v[100:101], v81 offset:4096
    ds_read_b64_tr_b16 v[102:103], v81 offset:4608
    v_mfma_f32_32x32x16_bf16 v[16:31], v[192:195], v[68:71], 0
    v_mfma_f32_32x32x16_bf16 v[32:47], v[196:199], v[64:67], 0
    v_mfma_f32_32x32x16_bf16 v[48:63], v[196:199], v[68:71], 0
    s_waitcnt lgkmcnt(6)
    v_mfma_f32_32x32x16_bf16 v[0:15], v[200:203], v[72:75], v[0:15]
    s_waitcnt vmcnt(8)
    ds_write_b128 v82, v[152:155] offset:6144
    ds_write_b128 v82, v[156:159] offset:7168
    ds_read_b64_tr_b16 v[64:65], v80 offset:6144
    ds_read_b64_tr_b16 v[66:67], v80 offset:6656
    ds_read_b64_tr_b16 v[68:69], v81 offset:6144
    ds_read_b64_tr_b16 v[70:71], v81 offset:6656
    v_mfma_f32_32x32x16_bf16 v[16:31], v[200:203], v[76:79], v[16:31]
    v_mfma_f32_32x32x16_bf16 v[32:47], v[204:207], v[72:75], v[32:47]
    v_mfma_f32_32x32x16_bf16 v[48:63], v[204:207], v[76:79], v[48:63]
    s_waitcnt lgkmcnt(6)
    v_mfma_f32_32x32x16_bf16 v[0:15], v[208:211], v[96:99], v[0:15]
    s_waitcnt vmcnt(6)
    ds_write_b128 v82, v[160:163] offset:0
    ds_write_b128 v82, v[164:167] offset:1024
    ds_read_b64_tr_b16 v[72:73], v80 offset:0
    ds_read_b64_tr_b16 v[74:75], v80 offset:512
    ds_read_b64_tr_b16 v[76:77], v81 offset:0
    ds_read_b64_tr_b16 v[78:79], v81 offset:512
    v_mfma_f32_32x32x16_bf16 v[16:31], v[208:211], v[100:103], v[16:31]
    v_mfma_f32_32x32x16_bf16 v[32:47], v[212:215], v[96:99], v[32:47]
    v_mfma_f32_32x32x16_bf16 v[48:63], v[212:215], v[100:103], v[48:63]
    s_waitcnt lgkmcnt(6)
    v_mfma_f32_32x32x16_bf16 v[0:15], v[216:219], v[64:67], v[0:15]
    s_waitcnt vmcnt(4)
    ds_write_b128 v82, v[168:171] offset:2048
    ds_write_b128 v82, v[172:175] offset:3072
    ds_read_b64_tr_b16 v[96:97], v80 offset:2048
    ds_read_b64_tr_b16 v[98:99], v80 offset:2560
    ds_read_b64_tr_b16 v[100:101], v81 offset:2048
    ds_read_b64_tr_b16 v[102:103], v81 offset:2560
    v_mfma_f32_32x32x16_bf16 v[16:31], v[216:219], v[68:71], v[16:31]
    v_mfma_f32_32x32x16_bf16 v[32:47], v[220:223], v[64:67], v[32:47]
    v_mfma_f32_32x32x16_bf16 v[48:63], v[220:223], v[68:71], v[48:63]
    s_waitcnt lgkmcnt(6)
    v_mfma_f32_32x32x16_bf16 v[0:15], v[224:227], v[72:75], v[0:15]
    s_waitcnt vmcnt(2)
    ds_write_b128 v82, v[176:179] offset:4096
    ds_write_b128 v82, v[180:183] offset:5120
    ds_read_b64_tr_b16 v[64:65], v80 offset:4096
    ds_read_b64_tr_b16 v[66:67], v80 offset:4608
    ds_read_b64_tr_b16 v[68:69], v81 offset:4096
    ds_read_b64_tr_b16 v[70:71], v81 offset:4608
    v_mfma_f32_32x32x16_bf16 v[16:31], v[224:227], v[76:79], v[16:31]
    v_mfma_f32_32x32x16_bf16 v[32:47], v[228:231], v[72:75], v[32:47]
    v_mfma_f32_32x32x16_bf16 v[48:63], v[228:231], v[76:79], v[48:63]
    s_waitcnt vmcnt(0)
    ds_write_b128 v82, v[184:187] offset:6144
    ds_write_b128 v82, v[188:191] offset:7168
    ds_read_b64_tr_b16 v[72:73], v80 offset:6144
    ds_read_b64_tr_b16 v[74:75], v80 offset:6656
    ds_read_b64_tr_b16 v[76:77], v81 offset:6144
    ds_read_b64_tr_b16 v[78:79], v81 offset:6656
    v_add_u32 v118, 98304, v83
    s_waitcnt lgkmcnt(12)
    v_mfma_f32_32x32x16_bf16 v[32:47], v[236:239], v[96:99], v[32:47]
    s_waitcnt lgkmcnt(6)
    v_mfma_f32_32x32x16_bf16 v[32:47], v[244:247], v[64:67], v[32:47]
    s_waitcnt lgkmcnt(0)
    v_mfma_f32_32x32x16_bf16 v[32:47], v[252:255], v[72:75], v[32:47]
    v_mfma_f32_32x32x16_bf16 v[48:63], v[236:239], v[100:103], v[48:63]
    v_mfma_f32_32x32x16_bf16 v[48:63], v[244:247], v[68:71], v[48:63]
    s_nop 9
    ds_write_b128 v118, v[32:35] offset:0
    ds_write_b128 v118, v[36:39] offset:1024
    v_mfma_f32_32x32x16_bf16 v[48:63], v[252:255], v[76:79], v[48:63]
    ds_write_b128 v118, v[40:43] offset:2048
    ds_write_b128 v118, v[44:47] offset:3072
    v_mfma_f32_32x32x16_bf16 v[0:15], v[232:235], v[96:99], v[0:15]
    v_mfma_f32_32x32x16_bf16 v[0:15], v[240:243], v[64:67], v[0:15]
    s_nop 7
    ds_write_b128 v118, v[48:51] offset:4096
    ds_write_b128 v118, v[52:55] offset:5120
    v_mfma_f32_32x32x16_bf16 v[0:15], v[248:251], v[72:75], v[0:15]
    ds_write_b128 v118, v[56:59] offset:6144
    ds_write_b128 v118, v[60:63] offset:7168
    v_mfma_f32_32x32x16_bf16 v[16:31], v[232:235], v[100:103], v[16:31]
    v_mfma_f32_32x32x16_bf16 v[16:31], v[240:243], v[68:71], v[16:31]
    s_nop 7
    ds_write_b128 v83, v[0:3] offset:0
    ds_write_b128 v83, v[4:7] offset:1024
    v_mfma_f32_32x32x16_bf16 v[16:31], v[248:251], v[76:79], v[16:31]
    ds_write_b128 v83, v[8:11] offset:2048
    ds_write_b128 v83, v[12:15] offset:3072
    s_nop 9
    ds_write_b128 v83, v[16:19] offset:4096
    ds_write_b128 v83, v[20:23] offset:5120
    ds_write_b128 v83, v[24:27] offset:6144
    ds_write_b128 v83, v[28:31] offset:7168
L_FINAL:
    s_waitcnt lgkmcnt(0)
    s_barrier
    ds_read_b128 v[0:3], v108 offset:0
    ds_read_b128 v[4:7], v108 offset:1024
    ds_read_b128 v[8:11], v109 offset:0
    ds_read_b128 v[12:15], v109 offset:1024
    ds_read_b128 v[16:19], v110 offset:0
    ds_read_b128 v[20:23], v110 offset:1024
    ds_read_b128 v[24:27], v111 offset:0
    ds_read_b128 v[28:31], v111 offset:1024
    ds_read_b128 v[32:35], v112 offset:0
    ds_read_b128 v[36:39], v112 offset:1024
    ds_read_b128 v[40:43], v113 offset:0
    ds_read_b128 v[44:47], v113 offset:1024
    ds_read_b128 v[48:51], v114 offset:0
    ds_read_b128 v[52:55], v114 offset:1024
    ds_read_b128 v[56:59], v115 offset:0
    ds_read_b128 v[60:63], v115 offset:1024
    s_waitcnt lgkmcnt(12)
    v_pk_add_f32 v[0:1], v[0:1], v[8:9]
    v_pk_add_f32 v[2:3], v[2:3], v[10:11]
    v_pk_add_f32 v[4:5], v[4:5], v[12:13]
    v_pk_add_f32 v[6:7], v[6:7], v[14:15]
    s_waitcnt lgkmcnt(8)
    v_pk_add_f32 v[16:17], v[16:17], v[24:25]
    v_pk_add_f32 v[18:19], v[18:19], v[26:27]
    v_pk_add_f32 v[20:21], v[20:21], v[28:29]
    v_pk_add_f32 v[22:23], v[22:23], v[30:31]
    v_pk_add_f32 v[0:1], v[0:1], v[16:17]
    v_pk_add_f32 v[2:3], v[2:3], v[18:19]
    v_pk_add_f32 v[4:5], v[4:5], v[20:21]
    v_pk_add_f32 v[6:7], v[6:7], v[22:23]
    s_waitcnt lgkmcnt(4)
    v_pk_add_f32 v[32:33], v[32:33], v[40:41]
    v_pk_add_f32 v[34:35], v[34:35], v[42:43]
    v_pk_add_f32 v[36:37], v[36:37], v[44:45]
    v_pk_add_f32 v[38:39], v[38:39], v[46:47]
    s_waitcnt lgkmcnt(0)
    v_pk_add_f32 v[48:49], v[48:49], v[56:57]
    v_pk_add_f32 v[50:51], v[50:51], v[58:59]
    v_pk_add_f32 v[52:53], v[52:53], v[60:61]
    v_pk_add_f32 v[54:55], v[54:55], v[62:63]
    v_pk_add_f32 v[32:33], v[32:33], v[48:49]
    v_pk_add_f32 v[34:35], v[34:35], v[50:51]
    v_pk_add_f32 v[36:37], v[36:37], v[52:53]
    v_pk_add_f32 v[38:39], v[38:39], v[54:55]
    v_pk_add_f32 v[0:1], v[0:1], v[32:33]
    v_pk_add_f32 v[2:3], v[2:3], v[34:35]
    v_pk_add_f32 v[4:5], v[4:5], v[36:37]
    v_pk_add_f32 v[6:7], v[6:7], v[38:39]
    v_cvt_pk_bf16_f32 v64, v0, v1
    v_cvt_pk_bf16_f32 v65, v2, v3
    v_cvt_pk_bf16_f32 v66, v4, v5
    v_cvt_pk_bf16_f32 v67, v6, v7
    s_nop 0
    v_permlane32_swap_b32 v64, v66
    v_permlane32_swap_b32 v65, v67
    buffer_store_dwordx4 v[64:67], v88, s[48:51], s14 offen
    s_lshl_b32 s9, s2, 3
    s_add_u32 s9, s9, s57
    s_cmp_lg_u32 s9, 4
    s_cbranch_scc1 L_NOBUMP
    v_mov_b32 v116, 0
    v_mov_b32 v117, s56
    s_mov_b64 exec, 1
    buffer_store_dword v117, v116, s[36:39], 0 offen sc1
    s_mov_b64 exec, -1
L_NOBUMP:
L_END:
    s_endpgm
.section .rodata,"a"
.p2align 6
.amdhsa_kernel parallel_sum__spectral_gfnet__glu_gated_bilinear__prompt_kernel
  .amdhsa_next_free_vgpr 256
  .amdhsa_next_free_sgpr 91
  .amdhsa_accum_offset 256
  .amdhsa_group_segment_fixed_size 0
  .amdhsa_kernarg_size 80
  .amdhsa_user_sgpr_count 2
  .amdhsa_user_sgpr_kernarg_segment_ptr 1
  .amdhsa_system_sgpr_workgroup_id_x 1
.end_amdhsa_kernel
.section .rodata,"a"
.p2align 8
.set tc0, 0x3f80
.set tc1, 0x3f80
.set tc2, 0x3f80
.set tc3, 0x3f80
.set tc4, 0x3f80
.set tc5, 0x3f80
.set tc6, 0x3f7f
.set tc7, 0x3f7f
.set tc8, 0x3f7f
.set tc9, 0x3f7e
.set tc10, 0x3f7e
.set tc11, 0x3f7e
.set tc12, 0x3f7d
.set tc13, 0x3f7d
.set tc14, 0x3f7c
.set tc15, 0x3f7c
.set tc16, 0x3f7b
.set tc17, 0x3f7a
.set tc18, 0x3f7a
.set tc19, 0x3f79
.set tc20, 0x3f78
.set tc21, 0x3f78
.set tc22, 0x3f77
.set tc23, 0x3f76
.set tc24, 0x3f75
.set tc25, 0x3f74
.set tc26, 0x3f73
.set tc27, 0x3f72
.set tc28, 0x3f71
.set tc29, 0x3f70
.set tc30, 0x3f6f
.set tc31, 0x3f6e
.set tc32, 0x3f6d
.set tc33, 0x3f6b
.set tc34, 0x3f6a
.set tc35, 0x3f69
.set tc36, 0x3f67
.set tc37, 0x3f66
.set tc38, 0x3f65
.set tc39, 0x3f63
.set tc40, 0x3f62
.set tc41, 0x3f60
.set tc42, 0x3f5f
.set tc43, 0x3f5d
.set tc44, 0x3f5c
.set tc45, 0x3f5a
.set tc46, 0x3f58
.set tc47, 0x3f57
.set tc48, 0x3f55
.set tc49, 0x3f53
.set tc50, 0x3f51
.set tc51, 0x3f4f
.set tc52, 0x3f4e
.set tc53, 0x3f4c
.set tc54, 0x3f4a
.set tc55, 0x3f48
.set tc56, 0x3f46
.set tc57, 0x3f44
.set tc58, 0x3f42
.set tc59, 0x3f40
.set tc60, 0x3f3e
.set tc61, 0x3f3c
.set tc62, 0x3f39
.set tc63, 0x3f37
.set tc64, 0x3f35
.set tc65, 0x3f33
.set tc66, 0x3f31
.set tc67, 0x3f2e
.set tc68, 0x3f2c
.set tc69, 0x3f2a
.set tc70, 0x3f27
.set tc71, 0x3f25
.set tc72, 0x3f22
.set tc73, 0x3f20
.set tc74, 0x3f1d
.set tc75, 0x3f1b
.set tc76, 0x3f18
.set tc77, 0x3f16
.set tc78, 0x3f13
.set tc79, 0x3f11
.set tc80, 0x3f0e
.set tc81, 0x3f0c
.set tc82, 0x3f09
.set tc83, 0x3f06
.set tc84, 0x3f04
.set tc85, 0x3f01
.set tc86, 0x3efc
.set tc87, 0x3ef7
.set tc88, 0x3ef1
.set tc89, 0x3eec
.set tc90, 0x3ee6
.set tc91, 0x3ee1
.set tc92, 0x3edb
.set tc93, 0x3ed5
.set tc94, 0x3ecf
.set tc95, 0x3eca
.set tc96, 0x3ec4
.set tc97, 0x3ebe
.set tc98, 0x3eb8
.set tc99, 0x3eb2
.set tc100, 0x3eac
.set tc101, 0x3ea7
.set tc102, 0x3ea1
.set tc103, 0x3e9b
.set tc104, 0x3e95
.set tc105, 0x3e8f
.set tc106, 0x3e89
.set tc107, 0x3e82
.set tc108, 0x3e79
.set tc109, 0x3e6d
.set tc110, 0x3e60
.set tc111, 0x3e54
.set tc112, 0x3e48
.set tc113, 0x3e3b
.set tc114, 0x3e2f
.set tc115, 0x3e23
.set tc116, 0x3e16
.set tc117, 0x3e0a
.set tc118, 0x3dfb
.set tc119, 0x3de2
.set tc120, 0x3dc9
.set tc121, 0x3db0
.set tc122, 0x3d97
.set tc123, 0x3d7b
.set tc124, 0x3d49
.set tc125, 0x3d17
.set tc126, 0x3cc9
.set tc127, 0x3c49
.set tc128, 0x248d
.set tc129, 0xbc49
.set tc130, 0xbcc9
.set tc131, 0xbd17
.set tc132, 0xbd49
.set tc133, 0xbd7b
.set tc134, 0xbd97
.set tc135, 0xbdb0
.set tc136, 0xbdc9
.set tc137, 0xbde2
.set tc138, 0xbdfb
.set tc139, 0xbe0a
.set tc140, 0xbe16
.set tc141, 0xbe23
.set tc142, 0xbe2f
.set tc143, 0xbe3b
.set tc144, 0xbe48
.set tc145, 0xbe54
.set tc146, 0xbe60
.set tc147, 0xbe6d
.set tc148, 0xbe79
.set tc149, 0xbe82
.set tc150, 0xbe89
.set tc151, 0xbe8f
.set tc152, 0xbe95
.set tc153, 0xbe9b
.set tc154, 0xbea1
.set tc155, 0xbea7
.set tc156, 0xbeac
.set tc157, 0xbeb2
.set tc158, 0xbeb8
.set tc159, 0xbebe
.set tc160, 0xbec4
.set tc161, 0xbeca
.set tc162, 0xbecf
.set tc163, 0xbed5
.set tc164, 0xbedb
.set tc165, 0xbee1
.set tc166, 0xbee6
.set tc167, 0xbeec
.set tc168, 0xbef1
.set tc169, 0xbef7
.set tc170, 0xbefc
.set tc171, 0xbf01
.set tc172, 0xbf04
.set tc173, 0xbf06
.set tc174, 0xbf09
.set tc175, 0xbf0c
.set tc176, 0xbf0e
.set tc177, 0xbf11
.set tc178, 0xbf13
.set tc179, 0xbf16
.set tc180, 0xbf18
.set tc181, 0xbf1b
.set tc182, 0xbf1d
.set tc183, 0xbf20
.set tc184, 0xbf22
.set tc185, 0xbf25
.set tc186, 0xbf27
.set tc187, 0xbf2a
.set tc188, 0xbf2c
.set tc189, 0xbf2e
.set tc190, 0xbf31
.set tc191, 0xbf33
.set tc192, 0xbf35
.set tc193, 0xbf37
.set tc194, 0xbf39
.set tc195, 0xbf3c
.set tc196, 0xbf3e
.set tc197, 0xbf40
.set tc198, 0xbf42
.set tc199, 0xbf44
.set tc200, 0xbf46
.set tc201, 0xbf48
.set tc202, 0xbf4a
.set tc203, 0xbf4c
.set tc204, 0xbf4e
.set tc205, 0xbf4f
.set tc206, 0xbf51
.set tc207, 0xbf53
.set tc208, 0xbf55
.set tc209, 0xbf57
.set tc210, 0xbf58
.set tc211, 0xbf5a
.set tc212, 0xbf5c
.set tc213, 0xbf5d
.set tc214, 0xbf5f
.set tc215, 0xbf60
.set tc216, 0xbf62
.set tc217, 0xbf63
.set tc218, 0xbf65
.set tc219, 0xbf66
.set tc220, 0xbf67
.set tc221, 0xbf69
.set tc222, 0xbf6a
.set tc223, 0xbf6b
.set tc224, 0xbf6d
.set tc225, 0xbf6e
.set tc226, 0xbf6f
.set tc227, 0xbf70
.set tc228, 0xbf71
.set tc229, 0xbf72
.set tc230, 0xbf73
.set tc231, 0xbf74
.set tc232, 0xbf75
.set tc233, 0xbf76
.set tc234, 0xbf77
.set tc235, 0xbf78
.set tc236, 0xbf78
.set tc237, 0xbf79
.set tc238, 0xbf7a
.set tc239, 0xbf7a
.set tc240, 0xbf7b
.set tc241, 0xbf7c
.set tc242, 0xbf7c
.set tc243, 0xbf7d
.set tc244, 0xbf7d
.set tc245, 0xbf7e
.set tc246, 0xbf7e
.set tc247, 0xbf7e
.set tc248, 0xbf7f
.set tc249, 0xbf7f
.set tc250, 0xbf7f
.set tc251, 0xbf80
.set tc252, 0xbf80
.set tc253, 0xbf80
.set tc254, 0xbf80
.set tc255, 0xbf80
.set tc256, 0xbf80
.set tc257, 0xbf80
.set tc258, 0xbf80
.set tc259, 0xbf80
.set tc260, 0xbf80
.set tc261, 0xbf80
.set tc262, 0xbf7f
.set tc263, 0xbf7f
.set tc264, 0xbf7f
.set tc265, 0xbf7e
.set tc266, 0xbf7e
.set tc267, 0xbf7e
.set tc268, 0xbf7d
.set tc269, 0xbf7d
.set tc270, 0xbf7c
.set tc271, 0xbf7c
.set tc272, 0xbf7b
.set tc273, 0xbf7a
.set tc274, 0xbf7a
.set tc275, 0xbf79
.set tc276, 0xbf78
.set tc277, 0xbf78
.set tc278, 0xbf77
.set tc279, 0xbf76
.set tc280, 0xbf75
.set tc281, 0xbf74
.set tc282, 0xbf73
.set tc283, 0xbf72
.set tc284, 0xbf71
.set tc285, 0xbf70
.set tc286, 0xbf6f
.set tc287, 0xbf6e
.set tc288, 0xbf6d
.set tc289, 0xbf6b
.set tc290, 0xbf6a
.set tc291, 0xbf69
.set tc292, 0xbf67
.set tc293, 0xbf66
.set tc294, 0xbf65
.set tc295, 0xbf63
.set tc296, 0xbf62
.set tc297, 0xbf60
.set tc298, 0xbf5f
.set tc299, 0xbf5d
.set tc300, 0xbf5c
.set tc301, 0xbf5a
.set tc302, 0xbf58
.set tc303, 0xbf57
.set tc304, 0xbf55
.set tc305, 0xbf53
.set tc306, 0xbf51
.set tc307, 0xbf4f
.set tc308, 0xbf4e
.set tc309, 0xbf4c
.set tc310, 0xbf4a
.set tc311, 0xbf48
.set tc312, 0xbf46
.set tc313, 0xbf44
.set tc314, 0xbf42
.set tc315, 0xbf40
.set tc316, 0xbf3e
.set tc317, 0xbf3c
.set tc318, 0xbf39
.set tc319, 0xbf37
.set tc320, 0xbf35
.set tc321, 0xbf33
.set tc322, 0xbf31
.set tc323, 0xbf2e
.set tc324, 0xbf2c
.set tc325, 0xbf2a
.set tc326, 0xbf27
.set tc327, 0xbf25
.set tc328, 0xbf22
.set tc329, 0xbf20
.set tc330, 0xbf1d
.set tc331, 0xbf1b
.set tc332, 0xbf18
.set tc333, 0xbf16
.set tc334, 0xbf13
.set tc335, 0xbf11
.set tc336, 0xbf0e
.set tc337, 0xbf0c
.set tc338, 0xbf09
.set tc339, 0xbf06
.set tc340, 0xbf04
.set tc341, 0xbf01
.set tc342, 0xbefc
.set tc343, 0xbef7
.set tc344, 0xbef1
.set tc345, 0xbeec
.set tc346, 0xbee6
.set tc347, 0xbee1
.set tc348, 0xbedb
.set tc349, 0xbed5
.set tc350, 0xbecf
.set tc351, 0xbeca
.set tc352, 0xbec4
.set tc353, 0xbebe
.set tc354, 0xbeb8
.set tc355, 0xbeb2
.set tc356, 0xbeac
.set tc357, 0xbea7
.set tc358, 0xbea1
.set tc359, 0xbe9b
.set tc360, 0xbe95
.set tc361, 0xbe8f
.set tc362, 0xbe89
.set tc363, 0xbe82
.set tc364, 0xbe79
.set tc365, 0xbe6d
.set tc366, 0xbe60
.set tc367, 0xbe54
.set tc368, 0xbe48
.set tc369, 0xbe3b
.set tc370, 0xbe2f
.set tc371, 0xbe23
.set tc372, 0xbe16
.set tc373, 0xbe0a
.set tc374, 0xbdfb
.set tc375, 0xbde2
.set tc376, 0xbdc9
.set tc377, 0xbdb0
.set tc378, 0xbd97
.set tc379, 0xbd7b
.set tc380, 0xbd49
.set tc381, 0xbd17
.set tc382, 0xbcc9
.set tc383, 0xbc49
.set tc384, 0xa554
.set tc385, 0x3c49
.set tc386, 0x3cc9
.set tc387, 0x3d17
.set tc388, 0x3d49
.set tc389, 0x3d7b
.set tc390, 0x3d97
.set tc391, 0x3db0
.set tc392, 0x3dc9
.set tc393, 0x3de2
.set tc394, 0x3dfb
.set tc395, 0x3e0a
.set tc396, 0x3e16
.set tc397, 0x3e23
.set tc398, 0x3e2f
.set tc399, 0x3e3b
.set tc400, 0x3e48
.set tc401, 0x3e54
.set tc402, 0x3e60
.set tc403, 0x3e6d
.set tc404, 0x3e79
.set tc405, 0x3e82
.set tc406, 0x3e89
.set tc407, 0x3e8f
.set tc408, 0x3e95
.set tc409, 0x3e9b
.set tc410, 0x3ea1
.set tc411, 0x3ea7
.set tc412, 0x3eac
.set tc413, 0x3eb2
.set tc414, 0x3eb8
.set tc415, 0x3ebe
.set tc416, 0x3ec4
.set tc417, 0x3eca
.set tc418, 0x3ecf
.set tc419, 0x3ed5
.set tc420, 0x3edb
.set tc421, 0x3ee1
.set tc422, 0x3ee6
.set tc423, 0x3eec
.set tc424, 0x3ef1
.set tc425, 0x3ef7
.set tc426, 0x3efc
.set tc427, 0x3f01
.set tc428, 0x3f04
.set tc429, 0x3f06
.set tc430, 0x3f09
.set tc431, 0x3f0c
.set tc432, 0x3f0e
.set tc433, 0x3f11
.set tc434, 0x3f13
.set tc435, 0x3f16
.set tc436, 0x3f18
.set tc437, 0x3f1b
.set tc438, 0x3f1d
.set tc439, 0x3f20
.set tc440, 0x3f22
.set tc441, 0x3f25
.set tc442, 0x3f27
.set tc443, 0x3f2a
.set tc444, 0x3f2c
.set tc445, 0x3f2e
.set tc446, 0x3f31
.set tc447, 0x3f33
.set tc448, 0x3f35
.set tc449, 0x3f37
.set tc450, 0x3f39
.set tc451, 0x3f3c
.set tc452, 0x3f3e
.set tc453, 0x3f40
.set tc454, 0x3f42
.set tc455, 0x3f44
.set tc456, 0x3f46
.set tc457, 0x3f48
.set tc458, 0x3f4a
.set tc459, 0x3f4c
.set tc460, 0x3f4e
.set tc461, 0x3f4f
.set tc462, 0x3f51
.set tc463, 0x3f53
.set tc464, 0x3f55
.set tc465, 0x3f57
.set tc466, 0x3f58
.set tc467, 0x3f5a
.set tc468, 0x3f5c
.set tc469, 0x3f5d
.set tc470, 0x3f5f
.set tc471, 0x3f60
.set tc472, 0x3f62
.set tc473, 0x3f63
.set tc474, 0x3f65
.set tc475, 0x3f66
.set tc476, 0x3f67
.set tc477, 0x3f69
.set tc478, 0x3f6a
.set tc479, 0x3f6b
.set tc480, 0x3f6d
.set tc481, 0x3f6e
.set tc482, 0x3f6f
.set tc483, 0x3f70
.set tc484, 0x3f71
.set tc485, 0x3f72
.set tc486, 0x3f73
.set tc487, 0x3f74
.set tc488, 0x3f75
.set tc489, 0x3f76
.set tc490, 0x3f77
.set tc491, 0x3f78
.set tc492, 0x3f78
.set tc493, 0x3f79
.set tc494, 0x3f7a
.set tc495, 0x3f7a
.set tc496, 0x3f7b
.set tc497, 0x3f7c
.set tc498, 0x3f7c
.set tc499, 0x3f7d
.set tc500, 0x3f7d
.set tc501, 0x3f7e
.set tc502, 0x3f7e
.set tc503, 0x3f7e
.set tc504, 0x3f7f
.set tc505, 0x3f7f
.set tc506, 0x3f7f
.set tc507, 0x3f80
.set tc508, 0x3f80
.set tc509, 0x3f80
.set tc510, 0x3f80
.set tc511, 0x3f80
.altmacro
.macro tent i
.short tc\i
.endm
tabE:
.set tb, 0
.rept 256
.set tl, 0
.rept 64
.set tc_, ((tb>>4)*32)+(tl&31)
.set tk, ((tc_&127)*2)+(tc_>>8)
.set td, ((tb&15)*16)+((tl>>5)*8)
.rept 8
.if ((tc_>>7)&1) == 0
tent %((td*tk)&511)
.elseif tk == 0
tent %((td*256)&511)
.else
tent %((td*tk+128)&511)
.endif
.set td, td+1
.endr
.set tl, tl+1
.endr
.set tb, tb+1
.endr
.noaltmacro
```
